```python
import torch

def _softmax(x, axis=-1):
    return torch.softmax(x, dim=axis)
def _gelu(x):
    return torch.nn.functional.gelu(x, approximate="tanh")
def _silu(x):
    return torch.nn.functional.silu(x)
def _sigmoid(x):
    return torch.sigmoid(x)
def _layernorm(x, axis=-1, eps=1e-5):
    m = x.mean(dim=axis, keepdim=True)
    v = x.var(dim=axis, keepdim=True, unbiased=False)
    return (x - m) / torch.sqrt(v + eps)
def _scatter_add(tgt, idx, src, axis=0):
    return tgt.clone().index_add_(axis, idx, src)
def _segment_sum(src, seg, n):
    out = torch.zeros((n,) + src.shape[1:], dtype=src.dtype)
    return out.index_add_(0, seg, src)
def _pad(x, pw):
    flat = tuple(v for pair in reversed(pw) for v in pair)
    return torch.nn.functional.pad(x, flat)

kernel_name = 'gated_mix__mha_block__glu_gated_reglu__prompt'

def setup_inputs():

    _w = (lambda a: (lambda t: t.to(torch.bfloat16) if t.is_floating_point() else t)(torch.as_tensor(a)))
    def _A_setup():
        B, S, D, H = 1, 2048, 512, 32
        return {
            "x": _w((lambda *s: torch.randn(*s, dtype=torch.bfloat16) * 0.05)(B, S, D)),
            "wqkv": _w((lambda *s: torch.randn(*s, dtype=torch.bfloat16) * 0.8)(D, 3 * D)),
            "wo": _w((lambda *s: torch.randn(*s, dtype=torch.bfloat16) * 0.05)(D, D)),
        }
    _A_in = _A_setup()

    def _B_setup():
        B, S, D, F = 1, 2048, 512, 1792
        return {
            "x": _w((lambda *s: torch.randn(*s, dtype=torch.bfloat16) * 0.05)(B, S, D)),
            "W_gate": _w((lambda *s: torch.randn(*s, dtype=torch.bfloat16) * 1.6)(D, F) * (2.0 / D) ** 0.5),
            "W_up": _w((lambda *s: torch.randn(*s, dtype=torch.bfloat16) * 1.6)(D, F) * (2.0 / D) ** 0.5),
            "W_down": _w((lambda *s: torch.randn(*s, dtype=torch.bfloat16) * 1.6)(F, D) * (1.0 / F) ** 0.5),
        }
    _B_in = _B_setup()

    return {
        "A_x": _A_in["x"],
        "A_wqkv": _A_in["wqkv"],
        "A_wo": _A_in["wo"],
        "B_x": _B_in["x"],
        "B_W_gate": _B_in["W_gate"],
        "B_W_up": _B_in["W_up"],
        "B_W_down": _B_in["W_down"],
        "gate_w": _w((lambda *s: torch.randn(*s, dtype=torch.bfloat16) * 0.05)(512) * 16.0),
    }

def reference(A_x, A_wqkv, A_wo, B_x, B_W_gate, B_W_up, B_W_down, gate_w):
    def _A_ref(x, wqkv, wo):
        B, S, D = x.shape
        H = 32
        Dh = D // H
        qkv = (lambda x, *d: x.permute(*d))((x @ wqkv).reshape(B, S, 3, H, Dh), 2, 0, 3, 1, 4)
        q, k, v = qkv[0], qkv[1], qkv[2]
        scores = torch.einsum("bhqd,bhkd->bhqk", q, k) * (Dh ** -0.5)
        p = _softmax(scores, axis=-1)
        o = torch.einsum("bhqk,bhkd->bhqd", p, v)
        return (lambda x, *d: x.permute(*d))(o, 0, 2, 1, 3).reshape(B, S, D) @ wo

    def _B_ref(x, W_gate, W_up, W_down):
        gate = torch.einsum("bsd,df->bsf", x, W_gate)
        up = torch.einsum("bsd,df->bsf", x, W_up)
        gate = gate * (lambda x, dt: x.to(dt))(gate > 0, gate.dtype)
        h = gate * up
        return torch.einsum("bsf,fd->bsd", h, W_down)

    x = A_x
    g = _sigmoid((x * gate_w).sum(-1, keepdims=True))
    a = _A_ref(x, A_wqkv, A_wo)
    b = _B_ref(x, B_W_gate, B_W_up, B_W_down)
    return g * a + (1 - g) * b
```

```asm
; @launch grid=(256,1,1) block=(768,1,1) lds=163840
.amdgcn_target "amdgcn-amd-amdhsa--gfx950"
.text
.globl gated_mix__mha_block__glu_gated_reglu__prompt_kernel
.p2align 8
.type gated_mix__mha_block__glu_gated_reglu__prompt_kernel,@function
gated_mix__mha_block__glu_gated_reglu__prompt_kernel:
    s_cmp_ge_u32 s2, 256
    s_cbranch_scc1 gated_mix__mha_block__glu_gated_reglu__prompt_kernel_end
    s_load_dwordx4 s[8:11], s[0:1], 0
    s_load_dwordx2 s[16:17], s[0:1], 16
    s_load_dwordx4 s[20:23], s[0:1], 32
    s_load_dwordx4 s[28:31], s[0:1], 48
    s_load_dwordx4 s[36:39], s[0:1], 64
    s_load_dwordx2 s[40:41], s[0:1], 80
    v_lshrrev_b32 v2, 6, v0
    v_and_b32 v1, 63, v0
    s_and_b32 s48, s2, 1
    s_lshl_b32 s48, s48, 4
    s_lshr_b32 s49, s2, 3
    s_and_b32 s4, s49, 15
    s_add_u32 s4, s4, s48
    s_lshr_b32 s49, s49, 4
    s_and_b32 s5, s2, 6
    s_add_u32 s5, s5, s49
    s_and_b32 s52, s2, 7
    s_lshl_b32 s52, s52, 2
    s_lshr_b32 s53, s2, 3
    s_and_b32 s48, s53, 3
    s_add_u32 s52, s52, s48
    s_lshr_b32 s53, s53, 2
    v_readfirstlane_b32 s6, v2
    s_cmp_ge_u32 s6, 8
    s_cbranch_scc1 gated_mix__mha_block__glu_gated_reglu__prompt_kernel_g
    s_cmp_ge_u32 s6, 4
    s_cbranch_scc1 gated_mix__mha_block__glu_gated_reglu__prompt_kernel_la
    s_cmp_ge_u32 s6, 2
    s_cbranch_scc1 gated_mix__mha_block__glu_gated_reglu__prompt_kernel_c1
    s_waitcnt lgkmcnt(0)
    s_mov_b32 s12, s10
    s_mov_b32 s13, s11
    s_mov_b32 s10, 2097152
    s_mov_b32 s11, 0x20000
    s_mov_b32 s14, 1572864
    s_mov_b32 s15, 0x20000
    s_mov_b32 s24, s22
    s_mov_b32 s25, s23
    s_mov_b32 s32, s30
    s_mov_b32 s33, s31
    s_mov_b32 s44, s38
    s_mov_b32 s45, s39
    s_mov_b32 s18, 524288
    s_mov_b32 s19, 0x20000
    s_mov_b32 s22, 1835008
    s_mov_b32 s23, 0x20000
    s_mov_b32 s26, 1835008
    s_mov_b32 s27, 0x20000
    s_mov_b32 s30, 1835008
    s_mov_b32 s31, 0x20000
    s_mov_b32 s34, 1024
    s_mov_b32 s35, 0x20000
    s_mov_b32 s38, 2097152
    s_mov_b32 s39, 0x20000
    s_mov_b32 s42, 25165824
    s_mov_b32 s43, 0x20000
    s_mov_b32 s46, 256
    s_mov_b32 s47, 0x20000
    s_cmp_eq_u32 s6, 0
    s_cbranch_scc0 gated_mix__mha_block__glu_gated_reglu__prompt_kernel_hk1
    s_branch gated_mix__mha_block__glu_gated_reglu__prompt_kernel_hkdone
gated_mix__mha_block__glu_gated_reglu__prompt_kernel_hk1:
    v_lshlrev_b32 v2, 2, v1
    v_add_u32 v2, 155648, v2
    v_mov_b32 v3, 0
    ds_write_b32 v2, v3
    s_waitcnt lgkmcnt(0)
    s_cmp_lg_u32 s2, 0
    s_cbranch_scc1 gated_mix__mha_block__glu_gated_reglu__prompt_kernel_hkdone
    s_memrealtime s[48:49]
    s_waitcnt lgkmcnt(0)
    s_or_b32 s48, s48, 1
    v_mov_b32 v2, 0
    v_mov_b32 v3, s48
    s_mov_b64 exec, 1
    buffer_store_dword v3, v2, s[44:47], 0 offen sc1
    s_mov_b64 exec, -1
gated_mix__mha_block__glu_gated_reglu__prompt_kernel_hkdone:
    s_barrier
    s_and_b32 s54, s6, 1
    v_mov_b32 v7, 0
    v_and_b32 v2, 31, v1
    v_lshrrev_b32 v3, 3, v2
    v_lshlrev_b32 v3, 10, v3
    v_and_b32 v4, 7, v2
    v_lshlrev_b32 v4, 7, v4
    v_add_u32 v3, v3, v4
    v_lshrrev_b32 v4, 1, v2
    v_and_b32 v4, 7, v4
    v_lshrrev_b32 v5, 5, v1
    v_xor_b32 v4, v4, v5
    v_lshlrev_b32 v4, 4, v4
    v_add_u32 v8, v3, v4
    s_lshl_b32 s48, s54, 12
    v_add_u32 v8, s48, v8
    v_xor_b32 v9, 32, v8
    v_xor_b32 v10, 64, v8
    v_xor_b32 v11, 96, v8
    v_and_b32 v2, 15, v1
    v_lshrrev_b32 v2, 2, v2
    v_lshlrev_b32 v12, 7, v2
    v_lshrrev_b32 v2, 1, v2
    v_lshlrev_b32 v2, 6, v2
    v_add_u32 v12, v12, v2
    v_lshlrev_b32 v2, 1, v1
    v_and_b32 v2, 32, v2
    v_add_u32 v12, v12, v2
    v_and_b32 v2, 3, v1
    v_lshlrev_b32 v2, 3, v2
    v_add_u32 v12, v12, v2
    v_lshrrev_b32 v2, 5, v1
    v_mul_u32_u24 v2, 1024, v2
    v_add_u32 v12, v12, v2
    v_add_u32 v12, 65536, v12
    v_and_b32 v2, 15, v1
    v_lshrrev_b32 v2, 2, v2
    v_lshlrev_b32 v13, 7, v2
    v_lshrrev_b32 v2, 1, v2
    v_xor_b32 v2, 1, v2
    v_lshlrev_b32 v2, 6, v2
    v_add_u32 v13, v13, v2
    v_lshlrev_b32 v2, 1, v1
    v_and_b32 v2, 32, v2
    v_add_u32 v13, v13, v2
    v_and_b32 v2, 3, v1
    v_lshlrev_b32 v2, 3, v2
    v_add_u32 v13, v13, v2
    v_lshrrev_b32 v2, 5, v1
    v_mul_u32_u24 v2, 1024, v2
    v_add_u32 v13, v13, v2
    v_add_u32 v13, 65536, v13
    s_barrier
    s_add_u32 s48, s4, 0
    s_and_b32 s48, s48, 7
    s_lshl_b32 s48, s48, 13
    v_add_u32 v125, s48, v8
    v_add_u32 v126, s48, v9
    v_add_u32 v127, s48, v10
    v_add_u32 v128, s48, v11
    ds_read_b128 v[64:67], v125 offset:0
    ds_read_b64_tr_b16 v[76:77], v12 offset:0
    ds_read_b64_tr_b16 v[78:79], v12 offset:512
    ds_read_b64_tr_b16 v[80:81], v13 offset:0
    ds_read_b64_tr_b16 v[82:83], v13 offset:512
    ds_read_b64_tr_b16 v[84:85], v12 offset:8192
    ds_read_b64_tr_b16 v[86:87], v12 offset:8704
    ds_read_b128 v[68:71], v126 offset:0
    ds_read_b64_tr_b16 v[88:89], v12 offset:2048
    ds_read_b64_tr_b16 v[90:91], v12 offset:2560
    ds_read_b64_tr_b16 v[92:93], v13 offset:2048
    ds_read_b64_tr_b16 v[94:95], v13 offset:2560
    ds_read_b64_tr_b16 v[96:97], v12 offset:10240
    ds_read_b64_tr_b16 v[98:99], v12 offset:10752
    s_waitcnt lgkmcnt(7)
    ds_read_b128 v[72:75], v127 offset:0
    ds_read_b64_tr_b16 v[100:101], v12 offset:4096
    ds_read_b64_tr_b16 v[102:103], v12 offset:4608
    ds_read_b64_tr_b16 v[104:105], v13 offset:4096
    ds_read_b64_tr_b16 v[106:107], v13 offset:4608
    ds_read_b64_tr_b16 v[108:109], v12 offset:12288
    ds_read_b64_tr_b16 v[110:111], v12 offset:12800
    v_mfma_f32_32x32x16_bf16 v[16:31], v[76:79], v[64:67], 0
    v_mfma_f32_32x32x16_bf16 v[32:47], v[80:83], v[64:67], 0
    v_mfma_f32_32x32x16_bf16 v[48:63], v[84:87], v[64:67], 0
    s_waitcnt lgkmcnt(7)
    ds_read_b128 v[64:67], v128 offset:0
    ds_read_b64_tr_b16 v[76:77], v12 offset:6144
    ds_read_b64_tr_b16 v[78:79], v12 offset:6656
    ds_read_b64_tr_b16 v[80:81], v13 offset:6144
    ds_read_b64_tr_b16 v[82:83], v13 offset:6656
    ds_read_b64_tr_b16 v[84:85], v12 offset:14336
    ds_read_b64_tr_b16 v[86:87], v12 offset:14848
    v_mfma_f32_32x32x16_bf16 v[16:31], v[88:91], v[68:71], v[16:31]
    v_mfma_f32_32x32x16_bf16 v[32:47], v[92:95], v[68:71], v[32:47]
    v_mfma_f32_32x32x16_bf16 v[48:63], v[96:99], v[68:71], v[48:63]
    s_waitcnt lgkmcnt(0)
    s_barrier
    v_add_u32 v14, 24576, v12
    v_add_u32 v15, 24576, v13
    s_add_u32 s48, s4, 1
    s_and_b32 s48, s48, 7
    s_lshl_b32 s48, s48, 13
    v_add_u32 v125, s48, v8
    v_add_u32 v126, s48, v9
    v_add_u32 v127, s48, v10
    v_add_u32 v128, s48, v11
    ds_read_b128 v[68:71], v125 offset:0
    ds_read_b64_tr_b16 v[88:89], v14 offset:0
    ds_read_b64_tr_b16 v[90:91], v14 offset:512
    ds_read_b64_tr_b16 v[92:93], v15 offset:0
    ds_read_b64_tr_b16 v[94:95], v15 offset:512
    ds_read_b64_tr_b16 v[96:97], v14 offset:8192
    ds_read_b64_tr_b16 v[98:99], v14 offset:8704
    v_mfma_f32_32x32x16_bf16 v[16:31], v[100:103], v[72:75], v[16:31]
    v_mfma_f32_32x32x16_bf16 v[32:47], v[104:107], v[72:75], v[32:47]
    v_mfma_f32_32x32x16_bf16 v[48:63], v[108:111], v[72:75], v[48:63]
    ds_read_b128 v[72:75], v126 offset:0
    ds_read_b64_tr_b16 v[100:101], v14 offset:2048
    ds_read_b64_tr_b16 v[102:103], v14 offset:2560
    ds_read_b64_tr_b16 v[104:105], v15 offset:2048
    ds_read_b64_tr_b16 v[106:107], v15 offset:2560
    ds_read_b64_tr_b16 v[108:109], v14 offset:10240
    ds_read_b64_tr_b16 v[110:111], v14 offset:10752
    v_mfma_f32_32x32x16_bf16 v[16:31], v[76:79], v[64:67], v[16:31]
    v_mfma_f32_32x32x16_bf16 v[32:47], v[80:83], v[64:67], v[32:47]
    v_mfma_f32_32x32x16_bf16 v[48:63], v[84:87], v[64:67], v[48:63]
    s_waitcnt lgkmcnt(7)
    ds_read_b128 v[64:67], v127 offset:0
    ds_read_b64_tr_b16 v[76:77], v14 offset:4096
    ds_read_b64_tr_b16 v[78:79], v14 offset:4608
    ds_read_b64_tr_b16 v[80:81], v15 offset:4096
    ds_read_b64_tr_b16 v[82:83], v15 offset:4608
    ds_read_b64_tr_b16 v[84:85], v14 offset:12288
    ds_read_b64_tr_b16 v[86:87], v14 offset:12800
    v_mfma_f32_32x32x16_bf16 v[16:31], v[88:91], v[68:71], v[16:31]
    v_mfma_f32_32x32x16_bf16 v[32:47], v[92:95], v[68:71], v[32:47]
    v_mfma_f32_32x32x16_bf16 v[48:63], v[96:99], v[68:71], v[48:63]
    s_waitcnt lgkmcnt(7)
    ds_read_b128 v[68:71], v128 offset:0
    ds_read_b64_tr_b16 v[88:89], v14 offset:6144
    ds_read_b64_tr_b16 v[90:91], v14 offset:6656
    ds_read_b64_tr_b16 v[92:93], v15 offset:6144
    ds_read_b64_tr_b16 v[94:95], v15 offset:6656
    ds_read_b64_tr_b16 v[96:97], v14 offset:14336
    ds_read_b64_tr_b16 v[98:99], v14 offset:14848
    v_mfma_f32_32x32x16_bf16 v[16:31], v[100:103], v[72:75], v[16:31]
    v_mfma_f32_32x32x16_bf16 v[32:47], v[104:107], v[72:75], v[32:47]
    v_mfma_f32_32x32x16_bf16 v[48:63], v[108:111], v[72:75], v[48:63]
    s_waitcnt lgkmcnt(0)
    s_barrier
    v_add_u32 v14, 49152, v12
    v_add_u32 v15, 49152, v13
    s_add_u32 s48, s4, 2
    s_and_b32 s48, s48, 7
    s_lshl_b32 s48, s48, 13
    v_add_u32 v125, s48, v8
    v_add_u32 v126, s48, v9
    v_add_u32 v127, s48, v10
    v_add_u32 v128, s48, v11
    ds_read_b128 v[72:75], v125 offset:0
    ds_read_b64_tr_b16 v[100:101], v14 offset:0
    ds_read_b64_tr_b16 v[102:103], v14 offset:512
    ds_read_b64_tr_b16 v[104:105], v15 offset:0
    ds_read_b64_tr_b16 v[106:107], v15 offset:512
    ds_read_b64_tr_b16 v[108:109], v14 offset:8192
    ds_read_b64_tr_b16 v[110:111], v14 offset:8704
    v_mfma_f32_32x32x16_bf16 v[16:31], v[76:79], v[64:67], v[16:31]
    v_mfma_f32_32x32x16_bf16 v[32:47], v[80:83], v[64:67], v[32:47]
    v_mfma_f32_32x32x16_bf16 v[48:63], v[84:87], v[64:67], v[48:63]
    ds_read_b128 v[64:67], v126 offset:0
    ds_read_b64_tr_b16 v[76:77], v14 offset:2048
    ds_read_b64_tr_b16 v[78:79], v14 offset:2560
    ds_read_b64_tr_b16 v[80:81], v15 offset:2048
    ds_read_b64_tr_b16 v[82:83], v15 offset:2560
    ds_read_b64_tr_b16 v[84:85], v14 offset:10240
    ds_read_b64_tr_b16 v[86:87], v14 offset:10752
    v_mfma_f32_32x32x16_bf16 v[16:31], v[88:91], v[68:71], v[16:31]
    v_mfma_f32_32x32x16_bf16 v[32:47], v[92:95], v[68:71], v[32:47]
    v_mfma_f32_32x32x16_bf16 v[48:63], v[96:99], v[68:71], v[48:63]
    s_waitcnt lgkmcnt(7)
    ds_read_b128 v[68:71], v127 offset:0
    ds_read_b64_tr_b16 v[88:89], v14 offset:4096
    ds_read_b64_tr_b16 v[90:91], v14 offset:4608
    ds_read_b64_tr_b16 v[92:93], v15 offset:4096
    ds_read_b64_tr_b16 v[94:95], v15 offset:4608
    ds_read_b64_tr_b16 v[96:97], v14 offset:12288
    ds_read_b64_tr_b16 v[98:99], v14 offset:12800
    v_mfma_f32_32x32x16_bf16 v[16:31], v[100:103], v[72:75], v[16:31]
    v_mfma_f32_32x32x16_bf16 v[32:47], v[104:107], v[72:75], v[32:47]
    v_mfma_f32_32x32x16_bf16 v[48:63], v[108:111], v[72:75], v[48:63]
    s_waitcnt lgkmcnt(7)
    ds_read_b128 v[72:75], v128 offset:0
    ds_read_b64_tr_b16 v[100:101], v14 offset:6144
    ds_read_b64_tr_b16 v[102:103], v14 offset:6656
    ds_read_b64_tr_b16 v[104:105], v15 offset:6144
    ds_read_b64_tr_b16 v[106:107], v15 offset:6656
    ds_read_b64_tr_b16 v[108:109], v14 offset:14336
    ds_read_b64_tr_b16 v[110:111], v14 offset:14848
    v_mfma_f32_32x32x16_bf16 v[16:31], v[76:79], v[64:67], v[16:31]
    v_mfma_f32_32x32x16_bf16 v[32:47], v[80:83], v[64:67], v[32:47]
    v_mfma_f32_32x32x16_bf16 v[48:63], v[84:87], v[64:67], v[48:63]
    s_waitcnt lgkmcnt(0)
    s_barrier
    s_add_u32 s48, s4, 3
    s_and_b32 s48, s48, 7
    s_lshl_b32 s48, s48, 13
    v_add_u32 v125, s48, v8
    v_add_u32 v126, s48, v9
    v_add_u32 v127, s48, v10
    v_add_u32 v128, s48, v11
    ds_read_b128 v[64:67], v125 offset:0
    ds_read_b64_tr_b16 v[76:77], v12 offset:0
    ds_read_b64_tr_b16 v[78:79], v12 offset:512
    ds_read_b64_tr_b16 v[80:81], v13 offset:0
    ds_read_b64_tr_b16 v[82:83], v13 offset:512
    ds_read_b64_tr_b16 v[84:85], v12 offset:8192
    ds_read_b64_tr_b16 v[86:87], v12 offset:8704
    v_mfma_f32_32x32x16_bf16 v[16:31], v[88:91], v[68:71], v[16:31]
    v_mfma_f32_32x32x16_bf16 v[32:47], v[92:95], v[68:71], v[32:47]
    v_mfma_f32_32x32x16_bf16 v[48:63], v[96:99], v[68:71], v[48:63]
    ds_read_b128 v[68:71], v126 offset:0
    ds_read_b64_tr_b16 v[88:89], v12 offset:2048
    ds_read_b64_tr_b16 v[90:91], v12 offset:2560
    ds_read_b64_tr_b16 v[92:93], v13 offset:2048
    ds_read_b64_tr_b16 v[94:95], v13 offset:2560
    ds_read_b64_tr_b16 v[96:97], v12 offset:10240
    ds_read_b64_tr_b16 v[98:99], v12 offset:10752
    v_mfma_f32_32x32x16_bf16 v[16:31], v[100:103], v[72:75], v[16:31]
    v_mfma_f32_32x32x16_bf16 v[32:47], v[104:107], v[72:75], v[32:47]
    v_mfma_f32_32x32x16_bf16 v[48:63], v[108:111], v[72:75], v[48:63]
    s_waitcnt lgkmcnt(7)
    ds_read_b128 v[72:75], v127 offset:0
    ds_read_b64_tr_b16 v[100:101], v12 offset:4096
    ds_read_b64_tr_b16 v[102:103], v12 offset:4608
    ds_read_b64_tr_b16 v[104:105], v13 offset:4096
    ds_read_b64_tr_b16 v[106:107], v13 offset:4608
    ds_read_b64_tr_b16 v[108:109], v12 offset:12288
    ds_read_b64_tr_b16 v[110:111], v12 offset:12800
    v_mfma_f32_32x32x16_bf16 v[16:31], v[76:79], v[64:67], v[16:31]
    v_mfma_f32_32x32x16_bf16 v[32:47], v[80:83], v[64:67], v[32:47]
    v_mfma_f32_32x32x16_bf16 v[48:63], v[84:87], v[64:67], v[48:63]
    s_waitcnt lgkmcnt(7)
    ds_read_b128 v[64:67], v128 offset:0
    ds_read_b64_tr_b16 v[76:77], v12 offset:6144
    ds_read_b64_tr_b16 v[78:79], v12 offset:6656
    ds_read_b64_tr_b16 v[80:81], v13 offset:6144
    ds_read_b64_tr_b16 v[82:83], v13 offset:6656
    ds_read_b64_tr_b16 v[84:85], v12 offset:14336
    ds_read_b64_tr_b16 v[86:87], v12 offset:14848
    v_mfma_f32_32x32x16_bf16 v[16:31], v[88:91], v[68:71], v[16:31]
    v_mfma_f32_32x32x16_bf16 v[32:47], v[92:95], v[68:71], v[32:47]
    v_mfma_f32_32x32x16_bf16 v[48:63], v[96:99], v[68:71], v[48:63]
    s_waitcnt lgkmcnt(0)
    s_barrier
    v_add_u32 v14, 24576, v12
    v_add_u32 v15, 24576, v13
    s_add_u32 s48, s4, 4
    s_and_b32 s48, s48, 7
    s_lshl_b32 s48, s48, 13
    v_add_u32 v125, s48, v8
    v_add_u32 v126, s48, v9
    v_add_u32 v127, s48, v10
    v_add_u32 v128, s48, v11
    ds_read_b128 v[68:71], v125 offset:0
    ds_read_b64_tr_b16 v[88:89], v14 offset:0
    ds_read_b64_tr_b16 v[90:91], v14 offset:512
    ds_read_b64_tr_b16 v[92:93], v15 offset:0
    ds_read_b64_tr_b16 v[94:95], v15 offset:512
    ds_read_b64_tr_b16 v[96:97], v14 offset:8192
    ds_read_b64_tr_b16 v[98:99], v14 offset:8704
    v_mfma_f32_32x32x16_bf16 v[16:31], v[100:103], v[72:75], v[16:31]
    v_mfma_f32_32x32x16_bf16 v[32:47], v[104:107], v[72:75], v[32:47]
    v_mfma_f32_32x32x16_bf16 v[48:63], v[108:111], v[72:75], v[48:63]
    ds_read_b128 v[72:75], v126 offset:0
    ds_read_b64_tr_b16 v[100:101], v14 offset:2048
    ds_read_b64_tr_b16 v[102:103], v14 offset:2560
    ds_read_b64_tr_b16 v[104:105], v15 offset:2048
    ds_read_b64_tr_b16 v[106:107], v15 offset:2560
    ds_read_b64_tr_b16 v[108:109], v14 offset:10240
    ds_read_b64_tr_b16 v[110:111], v14 offset:10752
    v_mfma_f32_32x32x16_bf16 v[16:31], v[76:79], v[64:67], v[16:31]
    v_mfma_f32_32x32x16_bf16 v[32:47], v[80:83], v[64:67], v[32:47]
    v_mfma_f32_32x32x16_bf16 v[48:63], v[84:87], v[64:67], v[48:63]
    s_waitcnt lgkmcnt(7)
    ds_read_b128 v[64:67], v127 offset:0
    ds_read_b64_tr_b16 v[76:77], v14 offset:4096
    ds_read_b64_tr_b16 v[78:79], v14 offset:4608
    ds_read_b64_tr_b16 v[80:81], v15 offset:4096
    ds_read_b64_tr_b16 v[82:83], v15 offset:4608
    ds_read_b64_tr_b16 v[84:85], v14 offset:12288
    ds_read_b64_tr_b16 v[86:87], v14 offset:12800
    v_mfma_f32_32x32x16_bf16 v[16:31], v[88:91], v[68:71], v[16:31]
    v_mfma_f32_32x32x16_bf16 v[32:47], v[92:95], v[68:71], v[32:47]
    v_mfma_f32_32x32x16_bf16 v[48:63], v[96:99], v[68:71], v[48:63]
    s_waitcnt lgkmcnt(7)
    ds_read_b128 v[68:71], v128 offset:0
    ds_read_b64_tr_b16 v[88:89], v14 offset:6144
    ds_read_b64_tr_b16 v[90:91], v14 offset:6656
    ds_read_b64_tr_b16 v[92:93], v15 offset:6144
    ds_read_b64_tr_b16 v[94:95], v15 offset:6656
    ds_read_b64_tr_b16 v[96:97], v14 offset:14336
    ds_read_b64_tr_b16 v[98:99], v14 offset:14848
    v_mfma_f32_32x32x16_bf16 v[16:31], v[100:103], v[72:75], v[16:31]
    v_mfma_f32_32x32x16_bf16 v[32:47], v[104:107], v[72:75], v[32:47]
    v_mfma_f32_32x32x16_bf16 v[48:63], v[108:111], v[72:75], v[48:63]
    s_waitcnt lgkmcnt(0)
    s_barrier
    buffer_load_dword v6, v7, s[44:47], 0 offen sc1
    v_add_u32 v14, 49152, v12
    v_add_u32 v15, 49152, v13
    s_add_u32 s48, s4, 5
    s_and_b32 s48, s48, 7
    s_lshl_b32 s48, s48, 13
    v_add_u32 v125, s48, v8
    v_add_u32 v126, s48, v9
    v_add_u32 v127, s48, v10
    v_add_u32 v128, s48, v11
    ds_read_b128 v[72:75], v125 offset:0
    ds_read_b64_tr_b16 v[100:101], v14 offset:0
    ds_read_b64_tr_b16 v[102:103], v14 offset:512
    ds_read_b64_tr_b16 v[104:105], v15 offset:0
    ds_read_b64_tr_b16 v[106:107], v15 offset:512
    ds_read_b64_tr_b16 v[108:109], v14 offset:8192
    ds_read_b64_tr_b16 v[110:111], v14 offset:8704
    v_mfma_f32_32x32x16_bf16 v[16:31], v[76:79], v[64:67], v[16:31]
    v_mfma_f32_32x32x16_bf16 v[32:47], v[80:83], v[64:67], v[32:47]
    v_mfma_f32_32x32x16_bf16 v[48:63], v[84:87], v[64:67], v[48:63]
    ds_read_b128 v[64:67], v126 offset:0
    ds_read_b64_tr_b16 v[76:77], v14 offset:2048
    ds_read_b64_tr_b16 v[78:79], v14 offset:2560
    ds_read_b64_tr_b16 v[80:81], v15 offset:2048
    ds_read_b64_tr_b16 v[82:83], v15 offset:2560
    ds_read_b64_tr_b16 v[84:85], v14 offset:10240
    ds_read_b64_tr_b16 v[86:87], v14 offset:10752
    v_mfma_f32_32x32x16_bf16 v[16:31], v[88:91], v[68:71], v[16:31]
    v_mfma_f32_32x32x16_bf16 v[32:47], v[92:95], v[68:71], v[32:47]
    v_mfma_f32_32x32x16_bf16 v[48:63], v[96:99], v[68:71], v[48:63]
    s_waitcnt lgkmcnt(7)
    ds_read_b128 v[68:71], v127 offset:0
    ds_read_b64_tr_b16 v[88:89], v14 offset:4096
    ds_read_b64_tr_b16 v[90:91], v14 offset:4608
    ds_read_b64_tr_b16 v[92:93], v15 offset:4096
    ds_read_b64_tr_b16 v[94:95], v15 offset:4608
    ds_read_b64_tr_b16 v[96:97], v14 offset:12288
    ds_read_b64_tr_b16 v[98:99], v14 offset:12800
    v_mfma_f32_32x32x16_bf16 v[16:31], v[100:103], v[72:75], v[16:31]
    v_mfma_f32_32x32x16_bf16 v[32:47], v[104:107], v[72:75], v[32:47]
    v_mfma_f32_32x32x16_bf16 v[48:63], v[108:111], v[72:75], v[48:63]
    s_waitcnt lgkmcnt(7)
    ds_read_b128 v[72:75], v128 offset:0
    ds_read_b64_tr_b16 v[100:101], v14 offset:6144
    ds_read_b64_tr_b16 v[102:103], v14 offset:6656
    ds_read_b64_tr_b16 v[104:105], v15 offset:6144
    ds_read_b64_tr_b16 v[106:107], v15 offset:6656
    ds_read_b64_tr_b16 v[108:109], v14 offset:14336
    ds_read_b64_tr_b16 v[110:111], v14 offset:14848
    v_mfma_f32_32x32x16_bf16 v[16:31], v[76:79], v[64:67], v[16:31]
    v_mfma_f32_32x32x16_bf16 v[32:47], v[80:83], v[64:67], v[32:47]
    v_mfma_f32_32x32x16_bf16 v[48:63], v[84:87], v[64:67], v[48:63]
    s_waitcnt lgkmcnt(0)
    s_barrier
    s_add_u32 s48, s4, 6
    s_and_b32 s48, s48, 7
    s_lshl_b32 s48, s48, 13
    v_add_u32 v125, s48, v8
    v_add_u32 v126, s48, v9
    v_add_u32 v127, s48, v10
    v_add_u32 v128, s48, v11
    ds_read_b128 v[64:67], v125 offset:0
    ds_read_b64_tr_b16 v[76:77], v12 offset:0
    ds_read_b64_tr_b16 v[78:79], v12 offset:512
    ds_read_b64_tr_b16 v[80:81], v13 offset:0
    ds_read_b64_tr_b16 v[82:83], v13 offset:512
    ds_read_b64_tr_b16 v[84:85], v12 offset:8192
    ds_read_b64_tr_b16 v[86:87], v12 offset:8704
    v_mfma_f32_32x32x16_bf16 v[16:31], v[88:91], v[68:71], v[16:31]
    v_mfma_f32_32x32x16_bf16 v[32:47], v[92:95], v[68:71], v[32:47]
    v_mfma_f32_32x32x16_bf16 v[48:63], v[96:99], v[68:71], v[48:63]
    ds_read_b128 v[68:71], v126 offset:0
    ds_read_b64_tr_b16 v[88:89], v12 offset:2048
    ds_read_b64_tr_b16 v[90:91], v12 offset:2560
    ds_read_b64_tr_b16 v[92:93], v13 offset:2048
    ds_read_b64_tr_b16 v[94:95], v13 offset:2560
    ds_read_b64_tr_b16 v[96:97], v12 offset:10240
    ds_read_b64_tr_b16 v[98:99], v12 offset:10752
    v_mfma_f32_32x32x16_bf16 v[16:31], v[100:103], v[72:75], v[16:31]
    v_mfma_f32_32x32x16_bf16 v[32:47], v[104:107], v[72:75], v[32:47]
    v_mfma_f32_32x32x16_bf16 v[48:63], v[108:111], v[72:75], v[48:63]
    s_waitcnt lgkmcnt(7)
    ds_read_b128 v[72:75], v127 offset:0
    ds_read_b64_tr_b16 v[100:101], v12 offset:4096
    ds_read_b64_tr_b16 v[102:103], v12 offset:4608
    ds_read_b64_tr_b16 v[104:105], v13 offset:4096
    ds_read_b64_tr_b16 v[106:107], v13 offset:4608
    ds_read_b64_tr_b16 v[108:109], v12 offset:12288
    ds_read_b64_tr_b16 v[110:111], v12 offset:12800
    v_mfma_f32_32x32x16_bf16 v[16:31], v[76:79], v[64:67], v[16:31]
    v_mfma_f32_32x32x16_bf16 v[32:47], v[80:83], v[64:67], v[32:47]
    v_mfma_f32_32x32x16_bf16 v[48:63], v[84:87], v[64:67], v[48:63]
    s_waitcnt lgkmcnt(7)
    ds_read_b128 v[64:67], v128 offset:0
    ds_read_b64_tr_b16 v[76:77], v12 offset:6144
    ds_read_b64_tr_b16 v[78:79], v12 offset:6656
    ds_read_b64_tr_b16 v[80:81], v13 offset:6144
    ds_read_b64_tr_b16 v[82:83], v13 offset:6656
    ds_read_b64_tr_b16 v[84:85], v12 offset:14336
    ds_read_b64_tr_b16 v[86:87], v12 offset:14848
    v_mfma_f32_32x32x16_bf16 v[16:31], v[88:91], v[68:71], v[16:31]
    v_mfma_f32_32x32x16_bf16 v[32:47], v[92:95], v[68:71], v[32:47]
    v_mfma_f32_32x32x16_bf16 v[48:63], v[96:99], v[68:71], v[48:63]
    s_waitcnt lgkmcnt(0)
    s_barrier
    v_add_u32 v14, 24576, v12
    v_add_u32 v15, 24576, v13
    s_add_u32 s48, s4, 7
    s_and_b32 s48, s48, 7
    s_lshl_b32 s48, s48, 13
    v_add_u32 v125, s48, v8
    v_add_u32 v126, s48, v9
    v_add_u32 v127, s48, v10
    v_add_u32 v128, s48, v11
    ds_read_b128 v[68:71], v125 offset:0
    ds_read_b64_tr_b16 v[88:89], v14 offset:0
    ds_read_b64_tr_b16 v[90:91], v14 offset:512
    ds_read_b64_tr_b16 v[92:93], v15 offset:0
    ds_read_b64_tr_b16 v[94:95], v15 offset:512
    ds_read_b64_tr_b16 v[96:97], v14 offset:8192
    ds_read_b64_tr_b16 v[98:99], v14 offset:8704
    v_mfma_f32_32x32x16_bf16 v[16:31], v[100:103], v[72:75], v[16:31]
    v_mfma_f32_32x32x16_bf16 v[32:47], v[104:107], v[72:75], v[32:47]
    v_mfma_f32_32x32x16_bf16 v[48:63], v[108:111], v[72:75], v[48:63]
    ds_read_b128 v[72:75], v126 offset:0
    ds_read_b64_tr_b16 v[100:101], v14 offset:2048
    ds_read_b64_tr_b16 v[102:103], v14 offset:2560
    ds_read_b64_tr_b16 v[104:105], v15 offset:2048
    ds_read_b64_tr_b16 v[106:107], v15 offset:2560
    ds_read_b64_tr_b16 v[108:109], v14 offset:10240
    ds_read_b64_tr_b16 v[110:111], v14 offset:10752
    v_mfma_f32_32x32x16_bf16 v[16:31], v[76:79], v[64:67], v[16:31]
    v_mfma_f32_32x32x16_bf16 v[32:47], v[80:83], v[64:67], v[32:47]
    v_mfma_f32_32x32x16_bf16 v[48:63], v[84:87], v[64:67], v[48:63]
    s_waitcnt lgkmcnt(7)
    ds_read_b128 v[64:67], v127 offset:0
    ds_read_b64_tr_b16 v[76:77], v14 offset:4096
    ds_read_b64_tr_b16 v[78:79], v14 offset:4608
    ds_read_b64_tr_b16 v[80:81], v15 offset:4096
    ds_read_b64_tr_b16 v[82:83], v15 offset:4608
    ds_read_b64_tr_b16 v[84:85], v14 offset:12288
    ds_read_b64_tr_b16 v[86:87], v14 offset:12800
    v_mfma_f32_32x32x16_bf16 v[16:31], v[88:91], v[68:71], v[16:31]
    v_mfma_f32_32x32x16_bf16 v[32:47], v[92:95], v[68:71], v[32:47]
    v_mfma_f32_32x32x16_bf16 v[48:63], v[96:99], v[68:71], v[48:63]
    s_waitcnt lgkmcnt(7)
    ds_read_b128 v[68:71], v128 offset:0
    ds_read_b64_tr_b16 v[88:89], v14 offset:6144
    ds_read_b64_tr_b16 v[90:91], v14 offset:6656
    ds_read_b64_tr_b16 v[92:93], v15 offset:6144
    ds_read_b64_tr_b16 v[94:95], v15 offset:6656
    ds_read_b64_tr_b16 v[96:97], v14 offset:14336
    ds_read_b64_tr_b16 v[98:99], v14 offset:14848
    v_mfma_f32_32x32x16_bf16 v[16:31], v[100:103], v[72:75], v[16:31]
    v_mfma_f32_32x32x16_bf16 v[32:47], v[104:107], v[72:75], v[32:47]
    v_mfma_f32_32x32x16_bf16 v[48:63], v[108:111], v[72:75], v[48:63]
    s_waitcnt lgkmcnt(0)
    v_mfma_f32_32x32x16_bf16 v[16:31], v[76:79], v[64:67], v[16:31]
    v_mfma_f32_32x32x16_bf16 v[32:47], v[80:83], v[64:67], v[32:47]
    v_mfma_f32_32x32x16_bf16 v[48:63], v[84:87], v[64:67], v[48:63]
    v_mfma_f32_32x32x16_bf16 v[16:31], v[88:91], v[68:71], v[16:31]
    v_mfma_f32_32x32x16_bf16 v[32:47], v[92:95], v[68:71], v[32:47]
    v_mfma_f32_32x32x16_bf16 v[48:63], v[96:99], v[68:71], v[48:63]
    s_lshl_b32 s55, s4, 1
    s_add_u32 s55, s55, s54
    s_lshl_b32 s55, s55, 10
    s_lshl_b32 s48, s5, 18
    s_add_u32 s55, s55, s48
    v_lshlrev_b32 v2, 4, v1
    v_and_b32 v3, 15, v1
    v_lshlrev_b32 v3, 4, v3
    v_lshrrev_b32 v4, 5, v1
    v_lshlrev_b32 v4, 8, v4
    v_add_u32 v3, v3, v4
    v_lshlrev_b32 v4, 12, v1
    v_and_b32 v4, 0x10000, v4
    v_add_u32 v3, v3, v4
    s_mov_b32 s50, 0x3eb8aa3b
    v_mul_f32 v16, s50, v16
    v_mul_f32 v17, s50, v17
    v_mul_f32 v18, s50, v18
    v_mul_f32 v19, s50, v19
    v_mul_f32 v20, s50, v20
    v_mul_f32 v21, s50, v21
    v_mul_f32 v22, s50, v22
    v_mul_f32 v23, s50, v23
    v_mul_f32 v24, s50, v24
    v_mul_f32 v25, s50, v25
    v_mul_f32 v26, s50, v26
    v_mul_f32 v27, s50, v27
    v_mul_f32 v28, s50, v28
    v_mul_f32 v29, s50, v29
    v_mul_f32 v30, s50, v30
    v_mul_f32 v31, s50, v31
    v_cvt_pk_bf16_f32 v112, v16, v17
    v_cvt_pk_bf16_f32 v113, v18, v19
    v_cvt_pk_bf16_f32 v114, v20, v21
    v_cvt_pk_bf16_f32 v115, v22, v23
    v_cvt_pk_bf16_f32 v116, v24, v25
    v_cvt_pk_bf16_f32 v117, v26, v27
    v_cvt_pk_bf16_f32 v118, v28, v29
    v_cvt_pk_bf16_f32 v119, v30, v31
    s_add_u32 s48, s55, 0
    s_add_u32 s49, s48, 65536
    buffer_store_dwordx4 v[112:115], v2, s[40:43], s48 offen sc1
    buffer_store_dwordx4 v[116:119], v2, s[40:43], s49 offen sc1
    v_mul_f32 v32, s50, v32
    v_mul_f32 v33, s50, v33
    v_mul_f32 v34, s50, v34
    v_mul_f32 v35, s50, v35
    v_mul_f32 v36, s50, v36
    v_mul_f32 v37, s50, v37
    v_mul_f32 v38, s50, v38
    v_mul_f32 v39, s50, v39
    v_mul_f32 v40, s50, v40
    v_mul_f32 v41, s50, v41
    v_mul_f32 v42, s50, v42
    v_mul_f32 v43, s50, v43
    v_mul_f32 v44, s50, v44
    v_mul_f32 v45, s50, v45
    v_mul_f32 v46, s50, v46
    v_mul_f32 v47, s50, v47
    v_cvt_pk_bf16_f32 v76, v32, v33
    v_cvt_pk_bf16_f32 v77, v34, v35
    v_cvt_pk_bf16_f32 v78, v36, v37
    v_cvt_pk_bf16_f32 v79, v38, v39
    v_cvt_pk_bf16_f32 v80, v40, v41
    v_cvt_pk_bf16_f32 v81, v42, v43
    v_cvt_pk_bf16_f32 v82, v44, v45
    v_cvt_pk_bf16_f32 v83, v46, v47
    s_add_u32 s48, s55, 131072
    s_add_u32 s49, s48, 65536
    buffer_store_dwordx4 v[76:79], v2, s[40:43], s48 offen sc1
    buffer_store_dwordx4 v[80:83], v2, s[40:43], s49 offen sc1
    v_cvt_pk_bf16_f32 v88, v48, v49
    v_cvt_pk_bf16_f32 v89, v50, v51
    v_cvt_pk_bf16_f32 v90, v52, v53
    v_cvt_pk_bf16_f32 v91, v54, v55
    v_cvt_pk_bf16_f32 v92, v56, v57
    v_cvt_pk_bf16_f32 v93, v58, v59
    v_cvt_pk_bf16_f32 v94, v60, v61
    v_cvt_pk_bf16_f32 v95, v62, v63
    s_add_u32 s48, s55, 2097152
    s_add_u32 s49, s48, 65536
    buffer_store_dwordx4 v[88:91], v2, s[40:43], s48 offen sc1
    buffer_store_dwordx4 v[92:95], v2, s[40:43], s49 offen sc1
    s_waitcnt vmcnt(0)
    v_readfirstlane_b32 s7, v6
    s_mov_b32 s49, 200000
gated_mix__mha_block__glu_gated_reglu__prompt_kernel_C0_tag:
    s_cmp_lg_u32 s7, 0
    s_cbranch_scc1 gated_mix__mha_block__glu_gated_reglu__prompt_kernel_C0_tagok
    buffer_load_dword v6, v7, s[44:47], 0 offen sc1
    s_waitcnt vmcnt(0)
    v_readfirstlane_b32 s7, v6
    s_sub_u32 s49, s49, 1
    s_cmp_lg_u32 s49, 0
    s_cbranch_scc1 gated_mix__mha_block__glu_gated_reglu__prompt_kernel_C0_tag
gated_mix__mha_block__glu_gated_reglu__prompt_kernel_C0_tagok:
    s_barrier
    s_branch gated_mix__mha_block__glu_gated_reglu__prompt_kernel_attn
gated_mix__mha_block__glu_gated_reglu__prompt_kernel_c1:
    s_waitcnt lgkmcnt(0)
    s_mov_b32 s12, s10
    s_mov_b32 s13, s11
    s_mov_b32 s10, 2097152
    s_mov_b32 s11, 0x20000
    s_mov_b32 s14, 1572864
    s_mov_b32 s15, 0x20000
    s_mov_b32 s24, s22
    s_mov_b32 s25, s23
    s_mov_b32 s32, s30
    s_mov_b32 s33, s31
    s_mov_b32 s44, s38
    s_mov_b32 s45, s39
    s_mov_b32 s18, 524288
    s_mov_b32 s19, 0x20000
    s_mov_b32 s22, 1835008
    s_mov_b32 s23, 0x20000
    s_mov_b32 s26, 1835008
    s_mov_b32 s27, 0x20000
    s_mov_b32 s30, 1835008
    s_mov_b32 s31, 0x20000
    s_mov_b32 s34, 1024
    s_mov_b32 s35, 0x20000
    s_mov_b32 s38, 2097152
    s_mov_b32 s39, 0x20000
    s_mov_b32 s42, 25165824
    s_mov_b32 s43, 0x20000
    s_mov_b32 s46, 256
    s_mov_b32 s47, 0x20000
    s_barrier
    s_and_b32 s54, s6, 1
    v_mov_b32 v7, 0
    v_and_b32 v2, 31, v1
    v_lshrrev_b32 v3, 3, v2
    v_lshlrev_b32 v3, 10, v3
    v_and_b32 v4, 7, v2
    v_lshlrev_b32 v4, 7, v4
    v_add_u32 v3, v3, v4
    v_lshrrev_b32 v4, 1, v2
    v_and_b32 v4, 7, v4
    v_lshrrev_b32 v5, 5, v1
    v_xor_b32 v4, v4, v5
    v_lshlrev_b32 v4, 4, v4
    v_add_u32 v8, v3, v4
    s_lshl_b32 s48, s54, 12
    v_add_u32 v8, s48, v8
    v_xor_b32 v9, 32, v8
    v_xor_b32 v10, 64, v8
    v_xor_b32 v11, 96, v8
    v_and_b32 v2, 15, v1
    v_lshrrev_b32 v2, 2, v2
    v_lshlrev_b32 v12, 7, v2
    v_lshrrev_b32 v2, 1, v2
    v_lshlrev_b32 v2, 6, v2
    v_add_u32 v12, v12, v2
    v_lshlrev_b32 v2, 1, v1
    v_and_b32 v2, 32, v2
    v_add_u32 v12, v12, v2
    v_and_b32 v2, 3, v1
    v_lshlrev_b32 v2, 3, v2
    v_add_u32 v12, v12, v2
    v_lshrrev_b32 v2, 5, v1
    v_mul_u32_u24 v2, 1024, v2
    v_add_u32 v12, v12, v2
    v_add_u32 v12, 65536, v12
    v_and_b32 v2, 15, v1
    v_lshrrev_b32 v2, 2, v2
    v_lshlrev_b32 v13, 7, v2
    v_lshrrev_b32 v2, 1, v2
    v_xor_b32 v2, 1, v2
    v_lshlrev_b32 v2, 6, v2
    v_add_u32 v13, v13, v2
    v_lshlrev_b32 v2, 1, v1
    v_and_b32 v2, 32, v2
    v_add_u32 v13, v13, v2
    v_and_b32 v2, 3, v1
    v_lshlrev_b32 v2, 3, v2
    v_add_u32 v13, v13, v2
    v_lshrrev_b32 v2, 5, v1
    v_mul_u32_u24 v2, 1024, v2
    v_add_u32 v13, v13, v2
    v_add_u32 v13, 65536, v13
    s_barrier
    s_add_u32 s48, s4, 0
    s_and_b32 s48, s48, 7
    s_lshl_b32 s48, s48, 13
    v_add_u32 v125, s48, v8
    v_add_u32 v126, s48, v9
    v_add_u32 v127, s48, v10
    v_add_u32 v128, s48, v11
    ds_read_b128 v[64:67], v125 offset:0
    ds_read_b64_tr_b16 v[76:77], v13 offset:8192
    ds_read_b64_tr_b16 v[78:79], v13 offset:8704
    ds_read_b64_tr_b16 v[80:81], v12 offset:16384
    ds_read_b64_tr_b16 v[82:83], v12 offset:16896
    ds_read_b64_tr_b16 v[84:85], v13 offset:16384
    ds_read_b64_tr_b16 v[86:87], v13 offset:16896
    ds_read_b128 v[68:71], v126 offset:0
    ds_read_b64_tr_b16 v[88:89], v13 offset:10240
    ds_read_b64_tr_b16 v[90:91], v13 offset:10752
    ds_read_b64_tr_b16 v[92:93], v12 offset:18432
    ds_read_b64_tr_b16 v[94:95], v12 offset:18944
    ds_read_b64_tr_b16 v[96:97], v13 offset:18432
    ds_read_b64_tr_b16 v[98:99], v13 offset:18944
    s_waitcnt lgkmcnt(7)
    ds_read_b128 v[72:75], v127 offset:0
    ds_read_b64_tr_b16 v[100:101], v13 offset:12288
    ds_read_b64_tr_b16 v[102:103], v13 offset:12800
    ds_read_b64_tr_b16 v[104:105], v12 offset:20480
    ds_read_b64_tr_b16 v[106:107], v12 offset:20992
    ds_read_b64_tr_b16 v[108:109], v13 offset:20480
    ds_read_b64_tr_b16 v[110:111], v13 offset:20992
    v_mfma_f32_32x32x16_bf16 v[16:31], v[76:79], v[64:67], 0
    v_mfma_f32_32x32x16_bf16 v[32:47], v[64:67], v[80:83], 0
    v_mfma_f32_32x32x16_bf16 v[48:63], v[64:67], v[84:87], 0
    s_waitcnt lgkmcnt(7)
    ds_read_b128 v[64:67], v128 offset:0
    ds_read_b64_tr_b16 v[76:77], v13 offset:14336
    ds_read_b64_tr_b16 v[78:79], v13 offset:14848
    ds_read_b64_tr_b16 v[80:81], v12 offset:22528
    ds_read_b64_tr_b16 v[82:83], v12 offset:23040
    ds_read_b64_tr_b16 v[84:85], v13 offset:22528
    ds_read_b64_tr_b16 v[86:87], v13 offset:23040
    v_mfma_f32_32x32x16_bf16 v[16:31], v[88:91], v[68:71], v[16:31]
    v_mfma_f32_32x32x16_bf16 v[32:47], v[68:71], v[92:95], v[32:47]
    v_mfma_f32_32x32x16_bf16 v[48:63], v[68:71], v[96:99], v[48:63]
    s_waitcnt lgkmcnt(0)
    s_barrier
    v_add_u32 v14, 24576, v12
    v_add_u32 v15, 24576, v13
    s_add_u32 s48, s4, 1
    s_and_b32 s48, s48, 7
    s_lshl_b32 s48, s48, 13
    v_add_u32 v125, s48, v8
    v_add_u32 v126, s48, v9
    v_add_u32 v127, s48, v10
    v_add_u32 v128, s48, v11
    ds_read_b128 v[68:71], v125 offset:0
    ds_read_b64_tr_b16 v[88:89], v15 offset:8192
    ds_read_b64_tr_b16 v[90:91], v15 offset:8704
    ds_read_b64_tr_b16 v[92:93], v14 offset:16384
    ds_read_b64_tr_b16 v[94:95], v14 offset:16896
    ds_read_b64_tr_b16 v[96:97], v15 offset:16384
    ds_read_b64_tr_b16 v[98:99], v15 offset:16896
    v_mfma_f32_32x32x16_bf16 v[16:31], v[100:103], v[72:75], v[16:31]
    v_mfma_f32_32x32x16_bf16 v[32:47], v[72:75], v[104:107], v[32:47]
    v_mfma_f32_32x32x16_bf16 v[48:63], v[72:75], v[108:111], v[48:63]
    ds_read_b128 v[72:75], v126 offset:0
    ds_read_b64_tr_b16 v[100:101], v15 offset:10240
    ds_read_b64_tr_b16 v[102:103], v15 offset:10752
    ds_read_b64_tr_b16 v[104:105], v14 offset:18432
    ds_read_b64_tr_b16 v[106:107], v14 offset:18944
    ds_read_b64_tr_b16 v[108:109], v15 offset:18432
    ds_read_b64_tr_b16 v[110:111], v15 offset:18944
    v_mfma_f32_32x32x16_bf16 v[16:31], v[76:79], v[64:67], v[16:31]
    v_mfma_f32_32x32x16_bf16 v[32:47], v[64:67], v[80:83], v[32:47]
    v_mfma_f32_32x32x16_bf16 v[48:63], v[64:67], v[84:87], v[48:63]
    s_waitcnt lgkmcnt(7)
    ds_read_b128 v[64:67], v127 offset:0
    ds_read_b64_tr_b16 v[76:77], v15 offset:12288
    ds_read_b64_tr_b16 v[78:79], v15 offset:12800
    ds_read_b64_tr_b16 v[80:81], v14 offset:20480
    ds_read_b64_tr_b16 v[82:83], v14 offset:20992
    ds_read_b64_tr_b16 v[84:85], v15 offset:20480
    ds_read_b64_tr_b16 v[86:87], v15 offset:20992
    v_mfma_f32_32x32x16_bf16 v[16:31], v[88:91], v[68:71], v[16:31]
    v_mfma_f32_32x32x16_bf16 v[32:47], v[68:71], v[92:95], v[32:47]
    v_mfma_f32_32x32x16_bf16 v[48:63], v[68:71], v[96:99], v[48:63]
    s_waitcnt lgkmcnt(7)
    ds_read_b128 v[68:71], v128 offset:0
    ds_read_b64_tr_b16 v[88:89], v15 offset:14336
    ds_read_b64_tr_b16 v[90:91], v15 offset:14848
    ds_read_b64_tr_b16 v[92:93], v14 offset:22528
    ds_read_b64_tr_b16 v[94:95], v14 offset:23040
    ds_read_b64_tr_b16 v[96:97], v15 offset:22528
    ds_read_b64_tr_b16 v[98:99], v15 offset:23040
    v_mfma_f32_32x32x16_bf16 v[16:31], v[100:103], v[72:75], v[16:31]
    v_mfma_f32_32x32x16_bf16 v[32:47], v[72:75], v[104:107], v[32:47]
    v_mfma_f32_32x32x16_bf16 v[48:63], v[72:75], v[108:111], v[48:63]
    s_waitcnt lgkmcnt(0)
    s_barrier
    v_add_u32 v14, 49152, v12
    v_add_u32 v15, 49152, v13
    s_add_u32 s48, s4, 2
    s_and_b32 s48, s48, 7
    s_lshl_b32 s48, s48, 13
    v_add_u32 v125, s48, v8
    v_add_u32 v126, s48, v9
    v_add_u32 v127, s48, v10
    v_add_u32 v128, s48, v11
    ds_read_b128 v[72:75], v125 offset:0
    ds_read_b64_tr_b16 v[100:101], v15 offset:8192
    ds_read_b64_tr_b16 v[102:103], v15 offset:8704
    ds_read_b64_tr_b16 v[104:105], v14 offset:16384
    ds_read_b64_tr_b16 v[106:107], v14 offset:16896
    ds_read_b64_tr_b16 v[108:109], v15 offset:16384
    ds_read_b64_tr_b16 v[110:111], v15 offset:16896
    v_mfma_f32_32x32x16_bf16 v[16:31], v[76:79], v[64:67], v[16:31]
    v_mfma_f32_32x32x16_bf16 v[32:47], v[64:67], v[80:83], v[32:47]
    v_mfma_f32_32x32x16_bf16 v[48:63], v[64:67], v[84:87], v[48:63]
    ds_read_b128 v[64:67], v126 offset:0
    ds_read_b64_tr_b16 v[76:77], v15 offset:10240
    ds_read_b64_tr_b16 v[78:79], v15 offset:10752
    ds_read_b64_tr_b16 v[80:81], v14 offset:18432
    ds_read_b64_tr_b16 v[82:83], v14 offset:18944
    ds_read_b64_tr_b16 v[84:85], v15 offset:18432
    ds_read_b64_tr_b16 v[86:87], v15 offset:18944
    v_mfma_f32_32x32x16_bf16 v[16:31], v[88:91], v[68:71], v[16:31]
    v_mfma_f32_32x32x16_bf16 v[32:47], v[68:71], v[92:95], v[32:47]
    v_mfma_f32_32x32x16_bf16 v[48:63], v[68:71], v[96:99], v[48:63]
    s_waitcnt lgkmcnt(7)
    ds_read_b128 v[68:71], v127 offset:0
    ds_read_b64_tr_b16 v[88:89], v15 offset:12288
    ds_read_b64_tr_b16 v[90:91], v15 offset:12800
    ds_read_b64_tr_b16 v[92:93], v14 offset:20480
    ds_read_b64_tr_b16 v[94:95], v14 offset:20992
    ds_read_b64_tr_b16 v[96:97], v15 offset:20480
    ds_read_b64_tr_b16 v[98:99], v15 offset:20992
    v_mfma_f32_32x32x16_bf16 v[16:31], v[100:103], v[72:75], v[16:31]
    v_mfma_f32_32x32x16_bf16 v[32:47], v[72:75], v[104:107], v[32:47]
    v_mfma_f32_32x32x16_bf16 v[48:63], v[72:75], v[108:111], v[48:63]
    s_waitcnt lgkmcnt(7)
    ds_read_b128 v[72:75], v128 offset:0
    ds_read_b64_tr_b16 v[100:101], v15 offset:14336
    ds_read_b64_tr_b16 v[102:103], v15 offset:14848
    ds_read_b64_tr_b16 v[104:105], v14 offset:22528
    ds_read_b64_tr_b16 v[106:107], v14 offset:23040
    ds_read_b64_tr_b16 v[108:109], v15 offset:22528
    ds_read_b64_tr_b16 v[110:111], v15 offset:23040
    v_mfma_f32_32x32x16_bf16 v[16:31], v[76:79], v[64:67], v[16:31]
    v_mfma_f32_32x32x16_bf16 v[32:47], v[64:67], v[80:83], v[32:47]
    v_mfma_f32_32x32x16_bf16 v[48:63], v[64:67], v[84:87], v[48:63]
    s_waitcnt lgkmcnt(0)
    s_barrier
    s_add_u32 s48, s4, 3
    s_and_b32 s48, s48, 7
    s_lshl_b32 s48, s48, 13
    v_add_u32 v125, s48, v8
    v_add_u32 v126, s48, v9
    v_add_u32 v127, s48, v10
    v_add_u32 v128, s48, v11
    ds_read_b128 v[64:67], v125 offset:0
    ds_read_b64_tr_b16 v[76:77], v13 offset:8192
    ds_read_b64_tr_b16 v[78:79], v13 offset:8704
    ds_read_b64_tr_b16 v[80:81], v12 offset:16384
    ds_read_b64_tr_b16 v[82:83], v12 offset:16896
    ds_read_b64_tr_b16 v[84:85], v13 offset:16384
    ds_read_b64_tr_b16 v[86:87], v13 offset:16896
    v_mfma_f32_32x32x16_bf16 v[16:31], v[88:91], v[68:71], v[16:31]
    v_mfma_f32_32x32x16_bf16 v[32:47], v[68:71], v[92:95], v[32:47]
    v_mfma_f32_32x32x16_bf16 v[48:63], v[68:71], v[96:99], v[48:63]
    ds_read_b128 v[68:71], v126 offset:0
    ds_read_b64_tr_b16 v[88:89], v13 offset:10240
    ds_read_b64_tr_b16 v[90:91], v13 offset:10752
    ds_read_b64_tr_b16 v[92:93], v12 offset:18432
    ds_read_b64_tr_b16 v[94:95], v12 offset:18944
    ds_read_b64_tr_b16 v[96:97], v13 offset:18432
    ds_read_b64_tr_b16 v[98:99], v13 offset:18944
    v_mfma_f32_32x32x16_bf16 v[16:31], v[100:103], v[72:75], v[16:31]
    v_mfma_f32_32x32x16_bf16 v[32:47], v[72:75], v[104:107], v[32:47]
    v_mfma_f32_32x32x16_bf16 v[48:63], v[72:75], v[108:111], v[48:63]
    s_waitcnt lgkmcnt(7)
    ds_read_b128 v[72:75], v127 offset:0
    ds_read_b64_tr_b16 v[100:101], v13 offset:12288
    ds_read_b64_tr_b16 v[102:103], v13 offset:12800
    ds_read_b64_tr_b16 v[104:105], v12 offset:20480
    ds_read_b64_tr_b16 v[106:107], v12 offset:20992
    ds_read_b64_tr_b16 v[108:109], v13 offset:20480
    ds_read_b64_tr_b16 v[110:111], v13 offset:20992
    v_mfma_f32_32x32x16_bf16 v[16:31], v[76:79], v[64:67], v[16:31]
    v_mfma_f32_32x32x16_bf16 v[32:47], v[64:67], v[80:83], v[32:47]
    v_mfma_f32_32x32x16_bf16 v[48:63], v[64:67], v[84:87], v[48:63]
    s_waitcnt lgkmcnt(7)
    ds_read_b128 v[64:67], v128 offset:0
    ds_read_b64_tr_b16 v[76:77], v13 offset:14336
    ds_read_b64_tr_b16 v[78:79], v13 offset:14848
    ds_read_b64_tr_b16 v[80:81], v12 offset:22528
    ds_read_b64_tr_b16 v[82:83], v12 offset:23040
    ds_read_b64_tr_b16 v[84:85], v13 offset:22528
    ds_read_b64_tr_b16 v[86:87], v13 offset:23040
    v_mfma_f32_32x32x16_bf16 v[16:31], v[88:91], v[68:71], v[16:31]
    v_mfma_f32_32x32x16_bf16 v[32:47], v[68:71], v[92:95], v[32:47]
    v_mfma_f32_32x32x16_bf16 v[48:63], v[68:71], v[96:99], v[48:63]
    s_waitcnt lgkmcnt(0)
    s_barrier
    v_add_u32 v14, 24576, v12
    v_add_u32 v15, 24576, v13
    s_add_u32 s48, s4, 4
    s_and_b32 s48, s48, 7
    s_lshl_b32 s48, s48, 13
    v_add_u32 v125, s48, v8
    v_add_u32 v126, s48, v9
    v_add_u32 v127, s48, v10
    v_add_u32 v128, s48, v11
    ds_read_b128 v[68:71], v125 offset:0
    ds_read_b64_tr_b16 v[88:89], v15 offset:8192
    ds_read_b64_tr_b16 v[90:91], v15 offset:8704
    ds_read_b64_tr_b16 v[92:93], v14 offset:16384
    ds_read_b64_tr_b16 v[94:95], v14 offset:16896
    ds_read_b64_tr_b16 v[96:97], v15 offset:16384
    ds_read_b64_tr_b16 v[98:99], v15 offset:16896
    v_mfma_f32_32x32x16_bf16 v[16:31], v[100:103], v[72:75], v[16:31]
    v_mfma_f32_32x32x16_bf16 v[32:47], v[72:75], v[104:107], v[32:47]
    v_mfma_f32_32x32x16_bf16 v[48:63], v[72:75], v[108:111], v[48:63]
    ds_read_b128 v[72:75], v126 offset:0
    ds_read_b64_tr_b16 v[100:101], v15 offset:10240
    ds_read_b64_tr_b16 v[102:103], v15 offset:10752
    ds_read_b64_tr_b16 v[104:105], v14 offset:18432
    ds_read_b64_tr_b16 v[106:107], v14 offset:18944
    ds_read_b64_tr_b16 v[108:109], v15 offset:18432
    ds_read_b64_tr_b16 v[110:111], v15 offset:18944
    v_mfma_f32_32x32x16_bf16 v[16:31], v[76:79], v[64:67], v[16:31]
    v_mfma_f32_32x32x16_bf16 v[32:47], v[64:67], v[80:83], v[32:47]
    v_mfma_f32_32x32x16_bf16 v[48:63], v[64:67], v[84:87], v[48:63]
    s_waitcnt lgkmcnt(7)
    ds_read_b128 v[64:67], v127 offset:0
    ds_read_b64_tr_b16 v[76:77], v15 offset:12288
    ds_read_b64_tr_b16 v[78:79], v15 offset:12800
    ds_read_b64_tr_b16 v[80:81], v14 offset:20480
    ds_read_b64_tr_b16 v[82:83], v14 offset:20992
    ds_read_b64_tr_b16 v[84:85], v15 offset:20480
    ds_read_b64_tr_b16 v[86:87], v15 offset:20992
    v_mfma_f32_32x32x16_bf16 v[16:31], v[88:91], v[68:71], v[16:31]
    v_mfma_f32_32x32x16_bf16 v[32:47], v[68:71], v[92:95], v[32:47]
    v_mfma_f32_32x32x16_bf16 v[48:63], v[68:71], v[96:99], v[48:63]
    s_waitcnt lgkmcnt(7)
    ds_read_b128 v[68:71], v128 offset:0
    ds_read_b64_tr_b16 v[88:89], v15 offset:14336
    ds_read_b64_tr_b16 v[90:91], v15 offset:14848
    ds_read_b64_tr_b16 v[92:93], v14 offset:22528
    ds_read_b64_tr_b16 v[94:95], v14 offset:23040
    ds_read_b64_tr_b16 v[96:97], v15 offset:22528
    ds_read_b64_tr_b16 v[98:99], v15 offset:23040
    v_mfma_f32_32x32x16_bf16 v[16:31], v[100:103], v[72:75], v[16:31]
    v_mfma_f32_32x32x16_bf16 v[32:47], v[72:75], v[104:107], v[32:47]
    v_mfma_f32_32x32x16_bf16 v[48:63], v[72:75], v[108:111], v[48:63]
    s_waitcnt lgkmcnt(0)
    s_barrier
    buffer_load_dword v6, v7, s[44:47], 0 offen sc1
    v_add_u32 v14, 49152, v12
    v_add_u32 v15, 49152, v13
    s_add_u32 s48, s4, 5
    s_and_b32 s48, s48, 7
    s_lshl_b32 s48, s48, 13
    v_add_u32 v125, s48, v8
    v_add_u32 v126, s48, v9
    v_add_u32 v127, s48, v10
    v_add_u32 v128, s48, v11
    ds_read_b128 v[72:75], v125 offset:0
    ds_read_b64_tr_b16 v[100:101], v15 offset:8192
    ds_read_b64_tr_b16 v[102:103], v15 offset:8704
    ds_read_b64_tr_b16 v[104:105], v14 offset:16384
    ds_read_b64_tr_b16 v[106:107], v14 offset:16896
    ds_read_b64_tr_b16 v[108:109], v15 offset:16384
    ds_read_b64_tr_b16 v[110:111], v15 offset:16896
    v_mfma_f32_32x32x16_bf16 v[16:31], v[76:79], v[64:67], v[16:31]
    v_mfma_f32_32x32x16_bf16 v[32:47], v[64:67], v[80:83], v[32:47]
    v_mfma_f32_32x32x16_bf16 v[48:63], v[64:67], v[84:87], v[48:63]
    ds_read_b128 v[64:67], v126 offset:0
    ds_read_b64_tr_b16 v[76:77], v15 offset:10240
    ds_read_b64_tr_b16 v[78:79], v15 offset:10752
    ds_read_b64_tr_b16 v[80:81], v14 offset:18432
    ds_read_b64_tr_b16 v[82:83], v14 offset:18944
    ds_read_b64_tr_b16 v[84:85], v15 offset:18432
    ds_read_b64_tr_b16 v[86:87], v15 offset:18944
    v_mfma_f32_32x32x16_bf16 v[16:31], v[88:91], v[68:71], v[16:31]
    v_mfma_f32_32x32x16_bf16 v[32:47], v[68:71], v[92:95], v[32:47]
    v_mfma_f32_32x32x16_bf16 v[48:63], v[68:71], v[96:99], v[48:63]
    s_waitcnt lgkmcnt(7)
    ds_read_b128 v[68:71], v127 offset:0
    ds_read_b64_tr_b16 v[88:89], v15 offset:12288
    ds_read_b64_tr_b16 v[90:91], v15 offset:12800
    ds_read_b64_tr_b16 v[92:93], v14 offset:20480
    ds_read_b64_tr_b16 v[94:95], v14 offset:20992
    ds_read_b64_tr_b16 v[96:97], v15 offset:20480
    ds_read_b64_tr_b16 v[98:99], v15 offset:20992
    v_mfma_f32_32x32x16_bf16 v[16:31], v[100:103], v[72:75], v[16:31]
    v_mfma_f32_32x32x16_bf16 v[32:47], v[72:75], v[104:107], v[32:47]
    v_mfma_f32_32x32x16_bf16 v[48:63], v[72:75], v[108:111], v[48:63]
    s_waitcnt lgkmcnt(7)
    ds_read_b128 v[72:75], v128 offset:0
    ds_read_b64_tr_b16 v[100:101], v15 offset:14336
    ds_read_b64_tr_b16 v[102:103], v15 offset:14848
    ds_read_b64_tr_b16 v[104:105], v14 offset:22528
    ds_read_b64_tr_b16 v[106:107], v14 offset:23040
    ds_read_b64_tr_b16 v[108:109], v15 offset:22528
    ds_read_b64_tr_b16 v[110:111], v15 offset:23040
    v_mfma_f32_32x32x16_bf16 v[16:31], v[76:79], v[64:67], v[16:31]
    v_mfma_f32_32x32x16_bf16 v[32:47], v[64:67], v[80:83], v[32:47]
    v_mfma_f32_32x32x16_bf16 v[48:63], v[64:67], v[84:87], v[48:63]
    s_waitcnt lgkmcnt(0)
    s_barrier
    s_add_u32 s48, s4, 6
    s_and_b32 s48, s48, 7
    s_lshl_b32 s48, s48, 13
    v_add_u32 v125, s48, v8
    v_add_u32 v126, s48, v9
    v_add_u32 v127, s48, v10
    v_add_u32 v128, s48, v11
    ds_read_b128 v[64:67], v125 offset:0
    ds_read_b64_tr_b16 v[76:77], v13 offset:8192
    ds_read_b64_tr_b16 v[78:79], v13 offset:8704
    ds_read_b64_tr_b16 v[80:81], v12 offset:16384
    ds_read_b64_tr_b16 v[82:83], v12 offset:16896
    ds_read_b64_tr_b16 v[84:85], v13 offset:16384
    ds_read_b64_tr_b16 v[86:87], v13 offset:16896
    v_mfma_f32_32x32x16_bf16 v[16:31], v[88:91], v[68:71], v[16:31]
    v_mfma_f32_32x32x16_bf16 v[32:47], v[68:71], v[92:95], v[32:47]
    v_mfma_f32_32x32x16_bf16 v[48:63], v[68:71], v[96:99], v[48:63]
    ds_read_b128 v[68:71], v126 offset:0
    ds_read_b64_tr_b16 v[88:89], v13 offset:10240
    ds_read_b64_tr_b16 v[90:91], v13 offset:10752
    ds_read_b64_tr_b16 v[92:93], v12 offset:18432
    ds_read_b64_tr_b16 v[94:95], v12 offset:18944
    ds_read_b64_tr_b16 v[96:97], v13 offset:18432
    ds_read_b64_tr_b16 v[98:99], v13 offset:18944
    v_mfma_f32_32x32x16_bf16 v[16:31], v[100:103], v[72:75], v[16:31]
    v_mfma_f32_32x32x16_bf16 v[32:47], v[72:75], v[104:107], v[32:47]
    v_mfma_f32_32x32x16_bf16 v[48:63], v[72:75], v[108:111], v[48:63]
    s_waitcnt lgkmcnt(7)
    ds_read_b128 v[72:75], v127 offset:0
    ds_read_b64_tr_b16 v[100:101], v13 offset:12288
    ds_read_b64_tr_b16 v[102:103], v13 offset:12800
    ds_read_b64_tr_b16 v[104:105], v12 offset:20480
    ds_read_b64_tr_b16 v[106:107], v12 offset:20992
    ds_read_b64_tr_b16 v[108:109], v13 offset:20480
    ds_read_b64_tr_b16 v[110:111], v13 offset:20992
    v_mfma_f32_32x32x16_bf16 v[16:31], v[76:79], v[64:67], v[16:31]
    v_mfma_f32_32x32x16_bf16 v[32:47], v[64:67], v[80:83], v[32:47]
    v_mfma_f32_32x32x16_bf16 v[48:63], v[64:67], v[84:87], v[48:63]
    s_waitcnt lgkmcnt(7)
    ds_read_b128 v[64:67], v128 offset:0
    ds_read_b64_tr_b16 v[76:77], v13 offset:14336
    ds_read_b64_tr_b16 v[78:79], v13 offset:14848
    ds_read_b64_tr_b16 v[80:81], v12 offset:22528
    ds_read_b64_tr_b16 v[82:83], v12 offset:23040
    ds_read_b64_tr_b16 v[84:85], v13 offset:22528
    ds_read_b64_tr_b16 v[86:87], v13 offset:23040
    v_mfma_f32_32x32x16_bf16 v[16:31], v[88:91], v[68:71], v[16:31]
    v_mfma_f32_32x32x16_bf16 v[32:47], v[68:71], v[92:95], v[32:47]
    v_mfma_f32_32x32x16_bf16 v[48:63], v[68:71], v[96:99], v[48:63]
    s_waitcnt lgkmcnt(0)
    s_barrier
    v_add_u32 v14, 24576, v12
    v_add_u32 v15, 24576, v13
    s_add_u32 s48, s4, 7
    s_and_b32 s48, s48, 7
    s_lshl_b32 s48, s48, 13
    v_add_u32 v125, s48, v8
    v_add_u32 v126, s48, v9
    v_add_u32 v127, s48, v10
    v_add_u32 v128, s48, v11
    ds_read_b128 v[68:71], v125 offset:0
    ds_read_b64_tr_b16 v[88:89], v15 offset:8192
    ds_read_b64_tr_b16 v[90:91], v15 offset:8704
    ds_read_b64_tr_b16 v[92:93], v14 offset:16384
    ds_read_b64_tr_b16 v[94:95], v14 offset:16896
    ds_read_b64_tr_b16 v[96:97], v15 offset:16384
    ds_read_b64_tr_b16 v[98:99], v15 offset:16896
    v_mfma_f32_32x32x16_bf16 v[16:31], v[100:103], v[72:75], v[16:31]
    v_mfma_f32_32x32x16_bf16 v[32:47], v[72:75], v[104:107], v[32:47]
    v_mfma_f32_32x32x16_bf16 v[48:63], v[72:75], v[108:111], v[48:63]
    ds_read_b128 v[72:75], v126 offset:0
    ds_read_b64_tr_b16 v[100:101], v15 offset:10240
    ds_read_b64_tr_b16 v[102:103], v15 offset:10752
    ds_read_b64_tr_b16 v[104:105], v14 offset:18432
    ds_read_b64_tr_b16 v[106:107], v14 offset:18944
    ds_read_b64_tr_b16 v[108:109], v15 offset:18432
    ds_read_b64_tr_b16 v[110:111], v15 offset:18944
    v_mfma_f32_32x32x16_bf16 v[16:31], v[76:79], v[64:67], v[16:31]
    v_mfma_f32_32x32x16_bf16 v[32:47], v[64:67], v[80:83], v[32:47]
    v_mfma_f32_32x32x16_bf16 v[48:63], v[64:67], v[84:87], v[48:63]
    s_waitcnt lgkmcnt(7)
    ds_read_b128 v[64:67], v127 offset:0
    ds_read_b64_tr_b16 v[76:77], v15 offset:12288
    ds_read_b64_tr_b16 v[78:79], v15 offset:12800
    ds_read_b64_tr_b16 v[80:81], v14 offset:20480
    ds_read_b64_tr_b16 v[82:83], v14 offset:20992
    ds_read_b64_tr_b16 v[84:85], v15 offset:20480
    ds_read_b64_tr_b16 v[86:87], v15 offset:20992
    v_mfma_f32_32x32x16_bf16 v[16:31], v[88:91], v[68:71], v[16:31]
    v_mfma_f32_32x32x16_bf16 v[32:47], v[68:71], v[92:95], v[32:47]
    v_mfma_f32_32x32x16_bf16 v[48:63], v[68:71], v[96:99], v[48:63]
    s_waitcnt lgkmcnt(7)
    ds_read_b128 v[68:71], v128 offset:0
    ds_read_b64_tr_b16 v[88:89], v15 offset:14336
    ds_read_b64_tr_b16 v[90:91], v15 offset:14848
    ds_read_b64_tr_b16 v[92:93], v14 offset:22528
    ds_read_b64_tr_b16 v[94:95], v14 offset:23040
    ds_read_b64_tr_b16 v[96:97], v15 offset:22528
    ds_read_b64_tr_b16 v[98:99], v15 offset:23040
    v_mfma_f32_32x32x16_bf16 v[16:31], v[100:103], v[72:75], v[16:31]
    v_mfma_f32_32x32x16_bf16 v[32:47], v[72:75], v[104:107], v[32:47]
    v_mfma_f32_32x32x16_bf16 v[48:63], v[72:75], v[108:111], v[48:63]
    s_waitcnt lgkmcnt(0)
    v_mfma_f32_32x32x16_bf16 v[16:31], v[76:79], v[64:67], v[16:31]
    v_mfma_f32_32x32x16_bf16 v[32:47], v[64:67], v[80:83], v[32:47]
    v_mfma_f32_32x32x16_bf16 v[48:63], v[64:67], v[84:87], v[48:63]
    v_mfma_f32_32x32x16_bf16 v[16:31], v[88:91], v[68:71], v[16:31]
    v_mfma_f32_32x32x16_bf16 v[32:47], v[68:71], v[92:95], v[32:47]
    v_mfma_f32_32x32x16_bf16 v[48:63], v[68:71], v[96:99], v[48:63]
    s_lshl_b32 s55, s4, 1
    s_add_u32 s55, s55, s54
    s_lshl_b32 s55, s55, 10
    s_lshl_b32 s48, s5, 18
    s_add_u32 s55, s55, s48
    v_lshlrev_b32 v2, 4, v1
    v_and_b32 v3, 15, v1
    v_lshlrev_b32 v3, 4, v3
    v_lshrrev_b32 v4, 5, v1
    v_lshlrev_b32 v4, 8, v4
    v_add_u32 v3, v3, v4
    v_lshlrev_b32 v4, 12, v1
    v_and_b32 v4, 0x10000, v4
    v_add_u32 v3, v3, v4
    s_mov_b32 s50, 0x3eb8aa3b
    v_cvt_pk_bf16_f32 v112, v16, v17
    v_cvt_pk_bf16_f32 v113, v18, v19
    v_cvt_pk_bf16_f32 v114, v20, v21
    v_cvt_pk_bf16_f32 v115, v22, v23
    v_cvt_pk_bf16_f32 v116, v24, v25
    v_cvt_pk_bf16_f32 v117, v26, v27
    v_cvt_pk_bf16_f32 v118, v28, v29
    v_cvt_pk_bf16_f32 v119, v30, v31
    s_add_u32 s48, s55, 2228224
    s_add_u32 s49, s48, 65536
    buffer_store_dwordx4 v[112:115], v2, s[40:43], s48 offen sc1
    buffer_store_dwordx4 v[116:119], v2, s[40:43], s49 offen sc1
    v_cvt_pk_bf16_f32 v76, v32, v33
    v_cvt_pk_bf16_f32 v77, v34, v35
    v_cvt_pk_bf16_f32 v78, v36, v37
    v_cvt_pk_bf16_f32 v79, v38, v39
    v_cvt_pk_bf16_f32 v80, v40, v41
    v_cvt_pk_bf16_f32 v81, v42, v43
    v_cvt_pk_bf16_f32 v82, v44, v45
    v_cvt_pk_bf16_f32 v83, v46, v47
    s_add_u32 s48, s55, 4194304
    buffer_store_dwordx4 v[76:79], v3, s[40:43], s48 offen sc1
    buffer_store_dwordx4 v[80:83], v3, s[40:43], s48 offen offset:512 sc1
    v_cvt_pk_bf16_f32 v88, v48, v49
    v_cvt_pk_bf16_f32 v89, v50, v51
    v_cvt_pk_bf16_f32 v90, v52, v53
    v_cvt_pk_bf16_f32 v91, v54, v55
    v_cvt_pk_bf16_f32 v92, v56, v57
    v_cvt_pk_bf16_f32 v93, v58, v59
    v_cvt_pk_bf16_f32 v94, v60, v61
    v_cvt_pk_bf16_f32 v95, v62, v63
    s_add_u32 s48, s55, 4325376
    buffer_store_dwordx4 v[88:91], v3, s[40:43], s48 offen sc1
    buffer_store_dwordx4 v[92:95], v3, s[40:43], s48 offen offset:512 sc1
    s_waitcnt vmcnt(0)
    v_readfirstlane_b32 s7, v6
    s_mov_b32 s49, 200000
gated_mix__mha_block__glu_gated_reglu__prompt_kernel_C1_tag:
    s_cmp_lg_u32 s7, 0
    s_cbranch_scc1 gated_mix__mha_block__glu_gated_reglu__prompt_kernel_C1_tagok
    buffer_load_dword v6, v7, s[44:47], 0 offen sc1
    s_waitcnt vmcnt(0)
    v_readfirstlane_b32 s7, v6
    s_sub_u32 s49, s49, 1
    s_cmp_lg_u32 s49, 0
    s_cbranch_scc1 gated_mix__mha_block__glu_gated_reglu__prompt_kernel_C1_tag
gated_mix__mha_block__glu_gated_reglu__prompt_kernel_C1_tagok:
    s_barrier
    s_branch gated_mix__mha_block__glu_gated_reglu__prompt_kernel_attn
gated_mix__mha_block__glu_gated_reglu__prompt_kernel_la:
    s_sub_u32 s54, s6, 4
    v_lshrrev_b32 v2, 2, v1
    v_and_b32 v2, 4, v2
    v_and_b32 v3, 7, v1
    v_xor_b32 v2, v2, v3
    v_lshlrev_b32 v2, 4, v2
    v_lshrrev_b32 v3, 3, v1
    v_mul_u32_u24 v3, 3072, v3
    v_add_u32 v7, v2, v3
    s_mul_i32 s48, s54, 3
    s_add_u32 s48, s48, 0
    s_and_b32 s49, s48, 7
    s_mul_i32 s49, s49, 24576
    s_lshr_b32 s48, s48, 3
    s_lshl_b32 s48, s48, 10
    s_add_u32 s58, s49, s48
    s_lshl_b32 s48, s5, 7
    s_add_u32 s58, s58, s48
    s_mul_i32 s48, s54, 3
    s_add_u32 s48, s48, 1
    s_and_b32 s49, s48, 7
    s_mul_i32 s49, s49, 24576
    s_lshr_b32 s48, s48, 3
    s_lshl_b32 s48, s48, 10
    s_add_u32 s59, s49, s48
    s_lshl_b32 s48, s5, 7
    s_add_u32 s59, s59, s48
    s_mul_i32 s48, s54, 3
    s_add_u32 s48, s48, 2
    s_and_b32 s49, s48, 7
    s_mul_i32 s49, s49, 24576
    s_lshr_b32 s48, s48, 3
    s_lshl_b32 s48, s48, 10
    s_add_u32 s60, s49, s48
    s_lshl_b32 s48, s5, 7
    s_add_u32 s60, s60, s48
    s_mul_i32 s57, s54, 3072
    s_add_u32 s57, s57, 65536
    s_and_b32 s48, s54, 1
    s_lshl_b32 s48, s48, 2
    v_lshrrev_b32 v2, 4, v1
    v_add_u32 v2, s48, v2
    v_and_b32 v3, 7, v1
    v_xor_b32 v2, v2, v3
    v_lshlrev_b32 v2, 4, v2
    v_lshrrev_b32 v3, 3, v1
    v_lshlrev_b32 v3, 10, v3
    v_add_u32 v6, v2, v3
    s_lshl_b32 s55, s4, 16
    s_lshl_b32 s48, s54, 13
    s_add_u32 s55, s55, s48
    s_lshl_b32 s56, s54, 10
    v_mov_b32 v9, 0
    s_waitcnt lgkmcnt(0)
    s_mov_b32 s12, s10
    s_mov_b32 s13, s11
    s_mov_b32 s10, 2097152
    s_mov_b32 s11, 0x20000
    s_mov_b32 s14, 1572864
    s_mov_b32 s15, 0x20000
    s_add_u32 s48, s4, 0
    s_and_b32 s48, s48, 7
    s_lshl_b32 s61, s48, 7
    s_add_u32 s61, s61, s55
    s_lshl_b32 s62, s48, 13
    s_add_u32 s62, s62, s56
    s_mul_i32 s63, s48, 196608
    s_mov_b32 m0, s62
    s_nop 0
    buffer_load_dwordx4 v6, s[8:11], s61 offen lds
    s_add_u32 s48, s4, 0
    s_and_b32 s48, s48, 7
    s_lshl_b32 s61, s48, 7
    s_add_u32 s61, s61, s55
    s_lshl_b32 s62, s48, 13
    s_add_u32 s62, s62, s56
    s_mul_i32 s63, s48, 196608
    s_add_u32 m0, s57, 0
    s_add_u32 s3, s58, s63
    buffer_load_dwordx4 v7, s[12:15], s3 offen lds
    s_add_u32 m0, s57, 1024
    s_add_u32 s3, s59, s63
    buffer_load_dwordx4 v7, s[12:15], s3 offen lds
    s_add_u32 m0, s57, 2048
    s_add_u32 s3, s60, s63
    buffer_load_dwordx4 v7, s[12:15], s3 offen lds
    s_mov_b32 s24, s22
    s_mov_b32 s25, s23
    s_mov_b32 s32, s30
    s_mov_b32 s33, s31
    s_mov_b32 s44, s38
    s_mov_b32 s45, s39
    s_mov_b32 s18, 524288
    s_mov_b32 s19, 0x20000
    s_mov_b32 s22, 1835008
    s_mov_b32 s23, 0x20000
    s_mov_b32 s26, 1835008
    s_mov_b32 s27, 0x20000
    s_mov_b32 s30, 1835008
    s_mov_b32 s31, 0x20000
    s_mov_b32 s34, 1024
    s_mov_b32 s35, 0x20000
    s_mov_b32 s38, 2097152
    s_mov_b32 s39, 0x20000
    s_mov_b32 s42, 25165824
    s_mov_b32 s43, 0x20000
    s_mov_b32 s46, 256
    s_mov_b32 s47, 0x20000
    s_barrier
    s_add_u32 s48, s4, 1
    s_and_b32 s48, s48, 7
    s_lshl_b32 s61, s48, 7
    s_add_u32 s61, s61, s55
    s_lshl_b32 s62, s48, 13
    s_add_u32 s62, s62, s56
    s_mul_i32 s63, s48, 196608
    s_mov_b32 m0, s62
    s_nop 0
    buffer_load_dwordx4 v6, s[8:11], s61 offen lds
    s_add_u32 s48, s4, 1
    s_and_b32 s48, s48, 7
    s_lshl_b32 s61, s48, 7
    s_add_u32 s61, s61, s55
    s_lshl_b32 s62, s48, 13
    s_add_u32 s62, s62, s56
    s_mul_i32 s63, s48, 196608
    s_add_u32 m0, s57, 24576
    s_add_u32 s3, s58, s63
    buffer_load_dwordx4 v7, s[12:15], s3 offen lds
    s_add_u32 m0, s57, 25600
    s_add_u32 s3, s59, s63
    buffer_load_dwordx4 v7, s[12:15], s3 offen lds
    s_add_u32 m0, s57, 26624
    s_add_u32 s3, s60, s63
    buffer_load_dwordx4 v7, s[12:15], s3 offen lds
    s_add_u32 s48, s4, 2
    s_and_b32 s48, s48, 7
    s_lshl_b32 s61, s48, 7
    s_add_u32 s61, s61, s55
    s_lshl_b32 s62, s48, 13
    s_add_u32 s62, s62, s56
    s_mul_i32 s63, s48, 196608
    s_mov_b32 m0, s62
    s_nop 0
    buffer_load_dwordx4 v6, s[8:11], s61 offen lds
    s_add_u32 s48, s4, 2
    s_and_b32 s48, s48, 7
    s_lshl_b32 s61, s48, 7
    s_add_u32 s61, s61, s55
    s_lshl_b32 s62, s48, 13
    s_add_u32 s62, s62, s56
    s_mul_i32 s63, s48, 196608
    s_add_u32 m0, s57, 49152
    s_add_u32 s3, s58, s63
    buffer_load_dwordx4 v7, s[12:15], s3 offen lds
    s_add_u32 m0, s57, 50176
    s_add_u32 s3, s59, s63
    buffer_load_dwordx4 v7, s[12:15], s3 offen lds
    s_add_u32 m0, s57, 51200
    s_add_u32 s3, s60, s63
    buffer_load_dwordx4 v7, s[12:15], s3 offen lds
    s_add_u32 s48, s4, 3
    s_and_b32 s48, s48, 7
    s_lshl_b32 s61, s48, 7
    s_add_u32 s61, s61, s55
    s_lshl_b32 s62, s48, 13
    s_add_u32 s62, s62, s56
    s_mul_i32 s63, s48, 196608
    s_mov_b32 m0, s62
    s_nop 0
    buffer_load_dwordx4 v6, s[8:11], s61 offen lds
    s_add_u32 s48, s4, 4
    s_and_b32 s48, s48, 7
    s_lshl_b32 s61, s48, 7
    s_add_u32 s61, s61, s55
    s_lshl_b32 s62, s48, 13
    s_add_u32 s62, s62, s56
    s_mul_i32 s63, s48, 196608
    s_mov_b32 m0, s62
    s_nop 0
    buffer_load_dwordx4 v6, s[8:11], s61 offen lds
    s_add_u32 s48, s4, 5
    s_and_b32 s48, s48, 7
    s_lshl_b32 s61, s48, 7
    s_add_u32 s61, s61, s55
    s_lshl_b32 s62, s48, 13
    s_add_u32 s62, s62, s56
    s_mul_i32 s63, s48, 196608
    s_mov_b32 m0, s62
    s_nop 0
    buffer_load_dwordx4 v6, s[8:11], s61 offen lds
    s_add_u32 s48, s4, 6
    s_and_b32 s48, s48, 7
    s_lshl_b32 s61, s48, 7
    s_add_u32 s61, s61, s55
    s_lshl_b32 s62, s48, 13
    s_add_u32 s62, s62, s56
    s_mul_i32 s63, s48, 196608
    s_mov_b32 m0, s62
    s_nop 0
    buffer_load_dwordx4 v6, s[8:11], s61 offen lds
    s_add_u32 s48, s4, 7
    s_and_b32 s48, s48, 7
    s_lshl_b32 s61, s48, 7
    s_add_u32 s61, s61, s55
    s_lshl_b32 s62, s48, 13
    s_add_u32 s62, s62, s56
    s_mul_i32 s63, s48, 196608
    s_mov_b32 m0, s62
    s_nop 0
    buffer_load_dwordx4 v6, s[8:11], s61 offen lds
    s_waitcnt vmcnt(13)
    s_barrier
    s_waitcnt vmcnt(9)
    s_barrier
    s_add_u32 s48, s4, 3
    s_and_b32 s48, s48, 7
    s_lshl_b32 s61, s48, 7
    s_add_u32 s61, s61, s55
    s_lshl_b32 s62, s48, 13
    s_add_u32 s62, s62, s56
    s_mul_i32 s63, s48, 196608
    s_add_u32 m0, s57, 0
    s_add_u32 s3, s58, s63
    buffer_load_dwordx4 v7, s[12:15], s3 offen lds
    s_add_u32 m0, s57, 1024
    s_add_u32 s3, s59, s63
    buffer_load_dwordx4 v7, s[12:15], s3 offen lds
    s_add_u32 m0, s57, 2048
    s_add_u32 s3, s60, s63
    buffer_load_dwordx4 v7, s[12:15], s3 offen lds
    s_waitcnt vmcnt(8)
    s_barrier
    s_add_u32 s48, s4, 4
    s_and_b32 s48, s48, 7
    s_lshl_b32 s61, s48, 7
    s_add_u32 s61, s61, s55
    s_lshl_b32 s62, s48, 13
    s_add_u32 s62, s62, s56
    s_mul_i32 s63, s48, 196608
    s_add_u32 m0, s57, 24576
    s_add_u32 s3, s58, s63
    buffer_load_dwordx4 v7, s[12:15], s3 offen lds
    s_add_u32 m0, s57, 25600
    s_add_u32 s3, s59, s63
    buffer_load_dwordx4 v7, s[12:15], s3 offen lds
    s_add_u32 m0, s57, 26624
    s_add_u32 s3, s60, s63
    buffer_load_dwordx4 v7, s[12:15], s3 offen lds
    s_waitcnt vmcnt(3)
    s_barrier
    s_add_u32 s48, s4, 5
    s_and_b32 s48, s48, 7
    s_lshl_b32 s61, s48, 7
    s_add_u32 s61, s61, s55
    s_lshl_b32 s62, s48, 13
    s_add_u32 s62, s62, s56
    s_mul_i32 s63, s48, 196608
    s_add_u32 m0, s57, 49152
    s_add_u32 s3, s58, s63
    buffer_load_dwordx4 v7, s[12:15], s3 offen lds
    s_add_u32 m0, s57, 50176
    s_add_u32 s3, s59, s63
    buffer_load_dwordx4 v7, s[12:15], s3 offen lds
    s_add_u32 m0, s57, 51200
    s_add_u32 s3, s60, s63
    buffer_load_dwordx4 v7, s[12:15], s3 offen lds
    s_waitcnt vmcnt(3)
    s_barrier
    s_add_u32 s48, s4, 6
    s_and_b32 s48, s48, 7
    s_lshl_b32 s61, s48, 7
    s_add_u32 s61, s61, s55
    s_lshl_b32 s62, s48, 13
    s_add_u32 s62, s62, s56
    s_mul_i32 s63, s48, 196608
    s_add_u32 m0, s57, 0
    s_add_u32 s3, s58, s63
    buffer_load_dwordx4 v7, s[12:15], s3 offen lds
    s_add_u32 m0, s57, 1024
    s_add_u32 s3, s59, s63
    buffer_load_dwordx4 v7, s[12:15], s3 offen lds
    s_add_u32 m0, s57, 2048
    s_add_u32 s3, s60, s63
    buffer_load_dwordx4 v7, s[12:15], s3 offen lds
    s_waitcnt vmcnt(3)
    s_barrier
    s_add_u32 s48, s4, 7
    s_and_b32 s48, s48, 7
    s_lshl_b32 s61, s48, 7
    s_add_u32 s61, s61, s55
    s_lshl_b32 s62, s48, 13
    s_add_u32 s62, s62, s56
    s_mul_i32 s63, s48, 196608
    s_add_u32 m0, s57, 24576
    s_add_u32 s3, s58, s63
    buffer_load_dwordx4 v7, s[12:15], s3 offen lds
    s_add_u32 m0, s57, 25600
    s_add_u32 s3, s59, s63
    buffer_load_dwordx4 v7, s[12:15], s3 offen lds
    s_add_u32 m0, s57, 26624
    s_add_u32 s3, s60, s63
    buffer_load_dwordx4 v7, s[12:15], s3 offen lds
    buffer_load_dword v8, v9, s[44:47], 0 offen sc1
    s_waitcnt vmcnt(4)
    s_barrier
    s_waitcnt vmcnt(1)
    s_barrier
    s_waitcnt vmcnt(0)
    v_readfirstlane_b32 s7, v8
    s_mov_b32 s49, 200000
gated_mix__mha_block__glu_gated_reglu__prompt_kernel_LA_tag:
    s_cmp_lg_u32 s7, 0
    s_cbranch_scc1 gated_mix__mha_block__glu_gated_reglu__prompt_kernel_LA_tagok
    buffer_load_dword v8, v9, s[44:47], 0 offen sc1
    s_waitcnt vmcnt(0)
    v_readfirstlane_b32 s7, v8
    s_sub_u32 s49, s49, 1
    s_cmp_lg_u32 s49, 0
    s_cbranch_scc1 gated_mix__mha_block__glu_gated_reglu__prompt_kernel_LA_tag
gated_mix__mha_block__glu_gated_reglu__prompt_kernel_LA_tagok:
    s_barrier
gated_mix__mha_block__glu_gated_reglu__prompt_kernel_attn:
    s_and_b32 s66, s2, 7
    s_lshr_b32 s67, s2, 3
    s_and_b32 s48, s67, 3
    s_lshl_b32 s54, s66, 2
    s_add_u32 s54, s54, s48
    s_lshl_b32 s54, s54, 16
    s_lshr_b32 s58, s67, 2
    s_lshl_b32 s58, s58, 3
    s_add_u32 s58, s58, s6
    v_lshlrev_b32 v8, 4, v1
    v_mov_b32 v12, 155648
    v_mov_b32 v13, 1
    s_cmp_lg_u32 s6, 0
    s_cbranch_scc1 gated_mix__mha_block__glu_gated_reglu__prompt_kernel_a_follow
    s_lshl_b32 s48, s5, 5
    s_add_u32 s48, s48, s4
    s_lshl_b32 s48, s48, 6
    s_add_u32 s48, s48, 8454144
    v_mov_b32 v2, 0
    v_mov_b32 v3, s7
    s_mov_b64 exec, 1
    buffer_store_dword v3, v2, s[40:43], s48 offen sc1
    s_mov_b64 exec, -1
    s_lshl_b32 s48, s66, 11
    s_add_u32 s48, s48, 8454144
    v_lshlrev_b32 v2, 6, v1
    s_mov_b32 exec_lo, 0xffffffff
    s_mov_b32 exec_hi, 0x0
    s_mov_b32 s59, 200000
gated_mix__mha_block__glu_gated_reglu__prompt_kernel_a_pollq:
    buffer_load_dword v3, v2, s[40:43], s48 offen sc1
    s_waitcnt vmcnt(0)
    v_cmp_ne_u32 vcc, s7, v3
    s_cbranch_vccz gated_mix__mha_block__glu_gated_reglu__prompt_kernel_a_pollq_ok
    s_sub_u32 s59, s59, 1
    s_cmp_eq_u32 s59, 0
    s_cbranch_scc1 gated_mix__mha_block__glu_gated_reglu__prompt_kernel_a_pollq_ok
    s_sleep 1
    s_branch gated_mix__mha_block__glu_gated_reglu__prompt_kernel_a_pollq
gated_mix__mha_block__glu_gated_reglu__prompt_kernel_a_pollq_ok:
    s_mov_b64 exec, -1
    s_mov_b64 exec, 1
    ds_write_b32 v12, v13 offset:68
    s_mov_b64 exec, -1
    s_branch gated_mix__mha_block__glu_gated_reglu__prompt_kernel_a_go
gated_mix__mha_block__glu_gated_reglu__prompt_kernel_a_follow:
    s_mov_b32 s59, 1600000
gated_mix__mha_block__glu_gated_reglu__prompt_kernel_a_spinq:
    ds_read_b32 v14, v12 offset:68
    s_waitcnt lgkmcnt(0)
    v_readfirstlane_b32 s60, v14
    s_cmp_ge_u32 s60, 1
    s_cbranch_scc1 gated_mix__mha_block__glu_gated_reglu__prompt_kernel_a_spinq_ok
    s_sub_u32 s59, s59, 1
    s_cmp_eq_u32 s59, 0
    s_cbranch_scc1 gated_mix__mha_block__glu_gated_reglu__prompt_kernel_a_spinq_ok
    s_sleep 1
    s_branch gated_mix__mha_block__glu_gated_reglu__prompt_kernel_a_spinq
gated_mix__mha_block__glu_gated_reglu__prompt_kernel_a_spinq_ok:
gated_mix__mha_block__glu_gated_reglu__prompt_kernel_a_go:
    s_lshl_b32 s48, s58, 10
    s_add_u32 s48, s48, s54
    s_add_u32 s48, s48, 0
    buffer_load_dwordx4 v[16:19], v8, s[40:43], s48 offen
    s_and_b32 s48, s6, 3
    s_lshl_b32 s48, s48, 10
    s_mov_b32 s49, 4194304
    s_cmp_lt_u32 s6, 4
    s_cselect_b32 s49, 2097152, s49
    s_add_u32 s55, s54, s48
    s_add_u32 s55, s55, s49
    s_lshl_b32 s56, s6, 10
    s_add_u32 s56, s56, 114688
    s_add_u32 m0, s56, 0
    s_add_u32 s3, s55, 0
    buffer_load_dwordx4 v8, s[40:43], s3 offen lds
    s_add_u32 m0, s56, 8192
    s_add_u32 s3, s55, 4096
    buffer_load_dwordx4 v8, s[40:43], s3 offen lds
    s_add_u32 m0, s56, 16384
    s_add_u32 s3, s55, 8192
    buffer_load_dwordx4 v8, s[40:43], s3 offen lds
    s_mov_b64 exec, 1
    ds_add_u32 v12, v13 offset:84
    s_mov_b64 exec, -1
    v_add_u32 v9, 114688, v8
    v_and_b32 v11, 15, v1
    v_lshlrev_b32 v11, 4, v11
    v_lshrrev_b32 v2, 5, v1
    v_lshlrev_b32 v2, 8, v2
    v_add_u32 v11, v11, v2
    v_add_u32 v10, 118784, v11
    s_mov_b32 s62, 0x0000ffff
    s_mov_b32 s63, 0x0000ffff
    v_and_b32 v2, 27, v1
    v_mov_b32 v3, 0x3f803f80
    v_cmp_eq_u32 vcc, 16, v2
    s_nop 1
    v_cndmask_b32 v2, 0, v3, vcc
    v_mov_b32 v24, v2
    v_mov_b32 v28, v2
    v_mov_b32 v25, v2
    v_mov_b32 v29, v2
    v_mov_b32 v26, v2
    v_mov_b32 v30, v2
    v_mov_b32 v27, v2
    v_mov_b32 v31, v2
    v_mov_b32 v64, 0
    v_mov_b32 v65, 0
    v_mov_b32 v66, 0
    v_mov_b32 v67, 0
    v_mov_b32 v68, 0
    v_mov_b32 v69, 0
    v_mov_b32 v70, 0
    v_mov_b32 v71, 0
    v_mov_b32 v72, 0
    v_mov_b32 v73, 0
    v_mov_b32 v74, 0
    v_mov_b32 v75, 0
    v_mov_b32 v76, 0
    v_mov_b32 v77, 0
    v_mov_b32 v78, 0
    v_mov_b32 v79, 0
    v_mov_b32 v80, 0
    v_mov_b32 v81, 0
    v_mov_b32 v82, 0
    v_mov_b32 v83, 0
    v_mov_b32 v84, 0
    v_mov_b32 v85, 0
    v_mov_b32 v86, 0
    v_mov_b32 v87, 0
    s_waitcnt vmcnt(2)
    s_mov_b64 exec, 1
    ds_add_u32 v12, v13 offset:72
    s_mov_b64 exec, -1
    s_mov_b32 s59, 1600000
gated_mix__mha_block__glu_gated_reglu__prompt_kernel_a_spin0:
    ds_read_b32 v14, v12 offset:72
    s_waitcnt lgkmcnt(0)
    v_readfirstlane_b32 s60, v14
    s_cmp_ge_u32 s60, 8
    s_cbranch_scc1 gated_mix__mha_block__glu_gated_reglu__prompt_kernel_a_spin0_ok
    s_sub_u32 s59, s59, 1
    s_cmp_eq_u32 s59, 0
    s_cbranch_scc1 gated_mix__mha_block__glu_gated_reglu__prompt_kernel_a_spin0_ok
    s_sleep 1
    s_branch gated_mix__mha_block__glu_gated_reglu__prompt_kernel_a_spin0
gated_mix__mha_block__glu_gated_reglu__prompt_kernel_a_spin0_ok:
    s_cmp_lt_u32 s6, 4
    s_cbranch_scc1 gated_mix__mha_block__glu_gated_reglu__prompt_kernel_a_old
    s_setprio 1
gated_mix__mha_block__glu_gated_reglu__prompt_kernel_a_old:
    s_mov_b32 s57, 0
    ds_read_b128 v[20:23], v9
    s_waitcnt lgkmcnt(0)
    v_mfma_f32_32x32x16_bf16 v[32:47], v[20:23], v[16:19], 0
    ds_read_b128 v[20:23], v9 offset:1024
    s_mov_b64 exec, s[62:63]
    ds_read_b128 v[24:27], v10
    ds_read_b128 v[28:31], v10
    s_mov_b64 exec, -1
    s_nop 7
gated_mix__mha_block__glu_gated_reglu__prompt_kernel_aloop:
    s_waitcnt lgkmcnt(2)
    v_mfma_f32_32x32x16_bf16 v[48:63], v[20:23], v[16:19], 0
    ds_read_b128 v[20:23], v9 offset:2048
    v_exp_f32 v32, v32
    v_exp_f32 v33, v33
    v_exp_f32 v34, v34
    v_exp_f32 v35, v35
    v_cvt_pk_bf16_f32 v64, v32, v33
    v_exp_f32 v36, v36
    v_cvt_pk_bf16_f32 v65, v34, v35
    v_exp_f32 v37, v37
    s_waitcnt lgkmcnt(1)
    v_mfma_f32_32x32x16_bf16 v[72:87], v[28:31], v[68:71], v[72:87]
    s_waitcnt vmcnt(1)
    s_mov_b64 exec, 1
    ds_add_u32 v12, v13 offset:0
    s_mov_b64 exec, -1
    v_exp_f32 v38, v38
    v_exp_f32 v39, v39
    v_cvt_pk_bf16_f32 v66, v36, v37
    v_exp_f32 v40, v40
    v_cvt_pk_bf16_f32 v67, v38, v39
    v_exp_f32 v41, v41
    v_exp_f32 v42, v42
    v_exp_f32 v43, v43
    v_mfma_f32_32x32x16_bf16 v[72:87], v[24:27], v[64:67], v[72:87]
    s_mov_b64 exec, s[62:63]
    ds_read_b128 v[24:27], v10 offset:1024
    ds_read_b128 v[28:31], v10 offset:512
    s_mov_b64 exec, -1
    v_cvt_pk_bf16_f32 v68, v40, v41
    v_exp_f32 v44, v44
    v_exp_f32 v45, v45
    v_cvt_pk_bf16_f32 v69, v42, v43
    v_exp_f32 v46, v46
    v_exp_f32 v47, v47
    v_cvt_pk_bf16_f32 v70, v44, v45
    v_cvt_pk_bf16_f32 v71, v46, v47
    s_waitcnt lgkmcnt(3)
    v_mfma_f32_32x32x16_bf16 v[32:47], v[20:23], v[16:19], 0
    ds_read_b128 v[20:23], v9 offset:3072
    v_exp_f32 v48, v48
    v_exp_f32 v49, v49
    v_exp_f32 v50, v50
    v_exp_f32 v51, v51
    v_cvt_pk_bf16_f32 v64, v48, v49
    v_exp_f32 v52, v52
    v_cvt_pk_bf16_f32 v65, v50, v51
    v_exp_f32 v53, v53
    s_waitcnt lgkmcnt(1)
    v_mfma_f32_32x32x16_bf16 v[72:87], v[28:31], v[68:71], v[72:87]
    ds_read_b32 v14, v12 offset:0
    v_exp_f32 v54, v54
    v_exp_f32 v55, v55
    v_cvt_pk_bf16_f32 v66, v52, v53
    v_exp_f32 v56, v56
    v_cvt_pk_bf16_f32 v67, v54, v55
    v_exp_f32 v57, v57
    v_exp_f32 v58, v58
    v_exp_f32 v59, v59
    v_mfma_f32_32x32x16_bf16 v[72:87], v[24:27], v[64:67], v[72:87]
    s_mov_b64 exec, s[62:63]
    ds_read_b128 v[24:27], v10 offset:2048
    ds_read_b128 v[28:31], v10 offset:1536
    s_mov_b64 exec, -1
    v_cvt_pk_bf16_f32 v68, v56, v57
    v_exp_f32 v60, v60
    v_exp_f32 v61, v61
    v_cvt_pk_bf16_f32 v69, v58, v59
    v_exp_f32 v62, v62
    v_exp_f32 v63, v63
    v_cvt_pk_bf16_f32 v70, v60, v61
    v_cvt_pk_bf16_f32 v71, v62, v63
    s_waitcnt lgkmcnt(2)
    v_readfirstlane_b32 s60, v14
    s_cmp_ge_u32 s60, 8
    s_cbranch_scc1 gated_mix__mha_block__glu_gated_reglu__prompt_kernel_asy0_ok
    s_mov_b32 s59, 1600000
gated_mix__mha_block__glu_gated_reglu__prompt_kernel_asy0:
    ds_read_b32 v14, v12 offset:0
    s_waitcnt lgkmcnt(0)
    v_readfirstlane_b32 s60, v14
    s_cmp_ge_u32 s60, 8
    s_cbranch_scc1 gated_mix__mha_block__glu_gated_reglu__prompt_kernel_asy0_ok
    s_sub_u32 s59, s59, 1
    s_cmp_eq_u32 s59, 0
    s_cbranch_scc1 gated_mix__mha_block__glu_gated_reglu__prompt_kernel_asy0_ok
    s_sleep 1
    s_branch gated_mix__mha_block__glu_gated_reglu__prompt_kernel_asy0
gated_mix__mha_block__glu_gated_reglu__prompt_kernel_asy0_ok:
    s_lshl_b32 s48, s57, 2
    s_add_u32 s48, s48, 19
    s_and_b32 s48, s48, 15
    s_lshl_b32 s48, s48, 12
    s_add_u32 m0, s56, 24576
    s_add_u32 s3, s55, s48
    buffer_load_dwordx4 v8, s[40:43], s3 offen lds
    v_mfma_f32_32x32x16_bf16 v[48:63], v[20:23], v[16:19], 0
    ds_read_b128 v[20:23], v9 offset:8192
    v_exp_f32 v32, v32
    v_exp_f32 v33, v33
    v_exp_f32 v34, v34
    v_exp_f32 v35, v35
    v_cvt_pk_bf16_f32 v64, v32, v33
    v_exp_f32 v36, v36
    v_cvt_pk_bf16_f32 v65, v34, v35
    v_exp_f32 v37, v37
    s_waitcnt lgkmcnt(1)
    v_mfma_f32_32x32x16_bf16 v[72:87], v[28:31], v[68:71], v[72:87]
    v_exp_f32 v38, v38
    v_exp_f32 v39, v39
    v_cvt_pk_bf16_f32 v66, v36, v37
    v_exp_f32 v40, v40
    v_cvt_pk_bf16_f32 v67, v38, v39
    v_exp_f32 v41, v41
    v_exp_f32 v42, v42
    v_exp_f32 v43, v43
    v_mfma_f32_32x32x16_bf16 v[72:87], v[24:27], v[64:67], v[72:87]
    s_mov_b64 exec, s[62:63]
    ds_read_b128 v[24:27], v10 offset:3072
    ds_read_b128 v[28:31], v10 offset:2560
    s_mov_b64 exec, -1
    v_cvt_pk_bf16_f32 v68, v40, v41
    v_exp_f32 v44, v44
    v_exp_f32 v45, v45
    v_cvt_pk_bf16_f32 v69, v42, v43
    v_exp_f32 v46, v46
    v_exp_f32 v47, v47
    v_cvt_pk_bf16_f32 v70, v44, v45
    v_cvt_pk_bf16_f32 v71, v46, v47
    s_waitcnt lgkmcnt(2)
    v_mfma_f32_32x32x16_bf16 v[32:47], v[20:23], v[16:19], 0
    ds_read_b128 v[20:23], v9 offset:9216
    v_exp_f32 v48, v48
    v_exp_f32 v49, v49
    v_exp_f32 v50, v50
    v_exp_f32 v51, v51
    v_cvt_pk_bf16_f32 v64, v48, v49
    v_exp_f32 v52, v52
    v_cvt_pk_bf16_f32 v65, v50, v51
    v_exp_f32 v53, v53
    s_waitcnt lgkmcnt(1)
    v_mfma_f32_32x32x16_bf16 v[72:87], v[28:31], v[68:71], v[72:87]
    v_exp_f32 v54, v54
    v_exp_f32 v55, v55
    v_cvt_pk_bf16_f32 v66, v52, v53
    v_exp_f32 v56, v56
    v_cvt_pk_bf16_f32 v67, v54, v55
    v_exp_f32 v57, v57
    v_exp_f32 v58, v58
    v_exp_f32 v59, v59
    v_mfma_f32_32x32x16_bf16 v[72:87], v[24:27], v[64:67], v[72:87]
    s_mov_b64 exec, s[62:63]
    ds_read_b128 v[24:27], v10 offset:8192
    ds_read_b128 v[28:31], v10 offset:3584
    s_mov_b64 exec, -1
    v_cvt_pk_bf16_f32 v68, v56, v57
    v_exp_f32 v60, v60
    v_exp_f32 v61, v61
    v_cvt_pk_bf16_f32 v69, v58, v59
    v_exp_f32 v62, v62
    v_exp_f32 v63, v63
    v_cvt_pk_bf16_f32 v70, v60, v61
    v_cvt_pk_bf16_f32 v71, v62, v63
    s_waitcnt lgkmcnt(2)
    v_mfma_f32_32x32x16_bf16 v[48:63], v[20:23], v[16:19], 0
    ds_read_b128 v[20:23], v9 offset:10240
    v_exp_f32 v32, v32
    v_exp_f32 v33, v33
    v_exp_f32 v34, v34
    v_exp_f32 v35, v35
    v_cvt_pk_bf16_f32 v64, v32, v33
    v_exp_f32 v36, v36
    v_cvt_pk_bf16_f32 v65, v34, v35
    v_exp_f32 v37, v37
    s_waitcnt lgkmcnt(1)
    v_mfma_f32_32x32x16_bf16 v[72:87], v[28:31], v[68:71], v[72:87]
    s_waitcnt vmcnt(1)
    s_mov_b64 exec, 1
    ds_add_u32 v12, v13 offset:4
    s_mov_b64 exec, -1
    v_exp_f32 v38, v38
    v_exp_f32 v39, v39
    v_cvt_pk_bf16_f32 v66, v36, v37
    v_exp_f32 v40, v40
    v_cvt_pk_bf16_f32 v67, v38, v39
    v_exp_f32 v41, v41
    v_exp_f32 v42, v42
    v_exp_f32 v43, v43
    v_mfma_f32_32x32x16_bf16 v[72:87], v[24:27], v[64:67], v[72:87]
    s_mov_b64 exec, s[62:63]
    ds_read_b128 v[24:27], v10 offset:9216
    ds_read_b128 v[28:31], v10 offset:8704
    s_mov_b64 exec, -1
    v_cvt_pk_bf16_f32 v68, v40, v41
    v_exp_f32 v44, v44
    v_exp_f32 v45, v45
    v_cvt_pk_bf16_f32 v69, v42, v43
    v_exp_f32 v46, v46
    v_exp_f32 v47, v47
    v_cvt_pk_bf16_f32 v70, v44, v45
    v_cvt_pk_bf16_f32 v71, v46, v47
    s_waitcnt lgkmcnt(3)
    v_mfma_f32_32x32x16_bf16 v[32:47], v[20:23], v[16:19], 0
    ds_read_b128 v[20:23], v9 offset:11264
    v_exp_f32 v48, v48
    v_exp_f32 v49, v49
    v_exp_f32 v50, v50
    v_exp_f32 v51, v51
    v_cvt_pk_bf16_f32 v64, v48, v49
    v_exp_f32 v52, v52
    v_cvt_pk_bf16_f32 v65, v50, v51
    v_exp_f32 v53, v53
    s_waitcnt lgkmcnt(1)
    v_mfma_f32_32x32x16_bf16 v[72:87], v[28:31], v[68:71], v[72:87]
    ds_read_b32 v14, v12 offset:4
    v_exp_f32 v54, v54
    v_exp_f32 v55, v55
    v_cvt_pk_bf16_f32 v66, v52, v53
    v_exp_f32 v56, v56
    v_cvt_pk_bf16_f32 v67, v54, v55
    v_exp_f32 v57, v57
    v_exp_f32 v58, v58
    v_exp_f32 v59, v59
    v_mfma_f32_32x32x16_bf16 v[72:87], v[24:27], v[64:67], v[72:87]
    s_mov_b64 exec, s[62:63]
    ds_read_b128 v[24:27], v10 offset:10240
    ds_read_b128 v[28:31], v10 offset:9728
    s_mov_b64 exec, -1
    v_cvt_pk_bf16_f32 v68, v56, v57
    v_exp_f32 v60, v60
    v_exp_f32 v61, v61
    v_cvt_pk_bf16_f32 v69, v58, v59
    v_exp_f32 v62, v62
    v_exp_f32 v63, v63
    v_cvt_pk_bf16_f32 v70, v60, v61
    v_cvt_pk_bf16_f32 v71, v62, v63
    s_waitcnt lgkmcnt(2)
    v_readfirstlane_b32 s60, v14
    s_cmp_ge_u32 s60, 8
    s_cbranch_scc1 gated_mix__mha_block__glu_gated_reglu__prompt_kernel_asy1_ok
    s_mov_b32 s59, 1600000
gated_mix__mha_block__glu_gated_reglu__prompt_kernel_asy1:
    ds_read_b32 v14, v12 offset:4
    s_waitcnt lgkmcnt(0)
    v_readfirstlane_b32 s60, v14
    s_cmp_ge_u32 s60, 8
    s_cbranch_scc1 gated_mix__mha_block__glu_gated_reglu__prompt_kernel_asy1_ok
    s_sub_u32 s59, s59, 1
    s_cmp_eq_u32 s59, 0
    s_cbranch_scc1 gated_mix__mha_block__glu_gated_reglu__prompt_kernel_asy1_ok
    s_sleep 1
    s_branch gated_mix__mha_block__glu_gated_reglu__prompt_kernel_asy1
gated_mix__mha_block__glu_gated_reglu__prompt_kernel_asy1_ok:
    s_cmp_eq_u32 s57, 3
    s_cbranch_scc1 gated_mix__mha_block__glu_gated_reglu__prompt_kernel_kvd1_1_nd
    s_lshl_b32 s48, s57, 2
    s_add_u32 s48, s48, 20
    s_and_b32 s48, s48, 15
    s_lshl_b32 s48, s48, 12
    s_add_u32 m0, s56, 0
    s_add_u32 s3, s55, s48
    buffer_load_dwordx4 v8, s[40:43], s3 offen lds
gated_mix__mha_block__glu_gated_reglu__prompt_kernel_kvd1_1_nd:
    v_mfma_f32_32x32x16_bf16 v[48:63], v[20:23], v[16:19], 0
    ds_read_b128 v[20:23], v9 offset:16384
    v_exp_f32 v32, v32
    v_exp_f32 v33, v33
    v_exp_f32 v34, v34
    v_exp_f32 v35, v35
    v_cvt_pk_bf16_f32 v64, v32, v33
    v_exp_f32 v36, v36
    v_cvt_pk_bf16_f32 v65, v34, v35
    v_exp_f32 v37, v37
    s_waitcnt lgkmcnt(1)
    v_mfma_f32_32x32x16_bf16 v[72:87], v[28:31], v[68:71], v[72:87]
    v_exp_f32 v38, v38
    v_exp_f32 v39, v39
    v_cvt_pk_bf16_f32 v66, v36, v37
    v_exp_f32 v40, v40
    v_cvt_pk_bf16_f32 v67, v38, v39
    v_exp_f32 v41, v41
    v_exp_f32 v42, v42
    v_exp_f32 v43, v43
    v_mfma_f32_32x32x16_bf16 v[72:87], v[24:27], v[64:67], v[72:87]
    s_mov_b64 exec, s[62:63]
    ds_read_b128 v[24:27], v10 offset:11264
    ds_read_b128 v[28:31], v10 offset:10752
    s_mov_b64 exec, -1
    v_cvt_pk_bf16_f32 v68, v40, v41
    v_exp_f32 v44, v44
    v_exp_f32 v45, v45
    v_cvt_pk_bf16_f32 v69, v42, v43
    v_exp_f32 v46, v46
    v_exp_f32 v47, v47
    v_cvt_pk_bf16_f32 v70, v44, v45
    v_cvt_pk_bf16_f32 v71, v46, v47
    s_waitcnt lgkmcnt(2)
    v_mfma_f32_32x32x16_bf16 v[32:47], v[20:23], v[16:19], 0
    ds_read_b128 v[20:23], v9 offset:17408
    v_exp_f32 v48, v48
    v_exp_f32 v49, v49
    v_exp_f32 v50, v50
    v_exp_f32 v51, v51
    v_cvt_pk_bf16_f32 v64, v48, v49
    v_exp_f32 v52, v52
    v_cvt_pk_bf16_f32 v65, v50, v51
    v_exp_f32 v53, v53
    s_waitcnt lgkmcnt(1)
    v_mfma_f32_32x32x16_bf16 v[72:87], v[28:31], v[68:71], v[72:87]
    v_exp_f32 v54, v54
    v_exp_f32 v55, v55
    v_cvt_pk_bf16_f32 v66, v52, v53
    v_exp_f32 v56, v56
    v_cvt_pk_bf16_f32 v67, v54, v55
    v_exp_f32 v57, v57
    v_exp_f32 v58, v58
    v_exp_f32 v59, v59
    v_mfma_f32_32x32x16_bf16 v[72:87], v[24:27], v[64:67], v[72:87]
    s_mov_b64 exec, s[62:63]
    ds_read_b128 v[24:27], v10 offset:16384
    ds_read_b128 v[28:31], v10 offset:11776
    s_mov_b64 exec, -1
    v_cvt_pk_bf16_f32 v68, v56, v57
    v_exp_f32 v60, v60
    v_exp_f32 v61, v61
    v_cvt_pk_bf16_f32 v69, v58, v59
    v_exp_f32 v62, v62
    v_exp_f32 v63, v63
    v_cvt_pk_bf16_f32 v70, v60, v61
    v_cvt_pk_bf16_f32 v71, v62, v63
    s_waitcnt lgkmcnt(2)
    v_mfma_f32_32x32x16_bf16 v[48:63], v[20:23], v[16:19], 0
    ds_read_b128 v[20:23], v9 offset:18432
    v_exp_f32 v32, v32
    v_exp_f32 v33, v33
    v_exp_f32 v34, v34
    v_exp_f32 v35, v35
    v_cvt_pk_bf16_f32 v64, v32, v33
    v_exp_f32 v36, v36
    v_cvt_pk_bf16_f32 v65, v34, v35
    v_exp_f32 v37, v37
    s_waitcnt lgkmcnt(1)
    v_mfma_f32_32x32x16_bf16 v[72:87], v[28:31], v[68:71], v[72:87]
    s_cmp_eq_u32 s57, 3
    s_cbranch_scc0 gated_mix__mha_block__glu_gated_reglu__prompt_kernel_aw2
    s_waitcnt vmcnt(0)
gated_mix__mha_block__glu_gated_reglu__prompt_kernel_aw2:
    s_waitcnt vmcnt(1)
    s_mov_b64 exec, 1
    ds_add_u32 v12, v13 offset:8
    s_mov_b64 exec, -1
    v_exp_f32 v38, v38
    v_exp_f32 v39, v39
    v_cvt_pk_bf16_f32 v66, v36, v37
    v_exp_f32 v40, v40
    v_cvt_pk_bf16_f32 v67, v38, v39
    v_exp_f32 v41, v41
    v_exp_f32 v42, v42
    v_exp_f32 v43, v43
    v_mfma_f32_32x32x16_bf16 v[72:87], v[24:27], v[64:67], v[72:87]
    s_mov_b64 exec, s[62:63]
    ds_read_b128 v[24:27], v10 offset:17408
    ds_read_b128 v[28:31], v10 offset:16896
    s_mov_b64 exec, -1
    v_cvt_pk_bf16_f32 v68, v40, v41
    v_exp_f32 v44, v44
    v_exp_f32 v45, v45
    v_cvt_pk_bf16_f32 v69, v42, v43
    v_exp_f32 v46, v46
    v_exp_f32 v47, v47
    v_cvt_pk_bf16_f32 v70, v44, v45
    v_cvt_pk_bf16_f32 v71, v46, v47
    s_waitcnt lgkmcnt(3)
    v_mfma_f32_32x32x16_bf16 v[32:47], v[20:23], v[16:19], 0
    ds_read_b128 v[20:23], v9 offset:19456
    v_exp_f32 v48, v48
    v_exp_f32 v49, v49
    v_exp_f32 v50, v50
    v_exp_f32 v51, v51
    v_cvt_pk_bf16_f32 v64, v48, v49
    v_exp_f32 v52, v52
    v_cvt_pk_bf16_f32 v65, v50, v51
    v_exp_f32 v53, v53
    s_waitcnt lgkmcnt(1)
    v_mfma_f32_32x32x16_bf16 v[72:87], v[28:31], v[68:71], v[72:87]
    ds_read_b32 v14, v12 offset:8
    v_exp_f32 v54, v54
    v_exp_f32 v55, v55
    v_cvt_pk_bf16_f32 v66, v52, v53
    v_exp_f32 v56, v56
    v_cvt_pk_bf16_f32 v67, v54, v55
    v_exp_f32 v57, v57
    v_exp_f32 v58, v58
    v_exp_f32 v59, v59
    v_mfma_f32_32x32x16_bf16 v[72:87], v[24:27], v[64:67], v[72:87]
    s_mov_b64 exec, s[62:63]
    ds_read_b128 v[24:27], v10 offset:18432
    ds_read_b128 v[28:31], v10 offset:17920
    s_mov_b64 exec, -1
    v_cvt_pk_bf16_f32 v68, v56, v57
    v_exp_f32 v60, v60
    v_exp_f32 v61, v61
    v_cvt_pk_bf16_f32 v69, v58, v59
    v_exp_f32 v62, v62
    v_exp_f32 v63, v63
    v_cvt_pk_bf16_f32 v70, v60, v61
    v_cvt_pk_bf16_f32 v71, v62, v63
    s_waitcnt lgkmcnt(2)
    v_readfirstlane_b32 s60, v14
    s_cmp_ge_u32 s60, 8
    s_cbranch_scc1 gated_mix__mha_block__glu_gated_reglu__prompt_kernel_asy2_ok
    s_mov_b32 s59, 1600000
gated_mix__mha_block__glu_gated_reglu__prompt_kernel_asy2:
    ds_read_b32 v14, v12 offset:8
    s_waitcnt lgkmcnt(0)
    v_readfirstlane_b32 s60, v14
    s_cmp_ge_u32 s60, 8
    s_cbranch_scc1 gated_mix__mha_block__glu_gated_reglu__prompt_kernel_asy2_ok
    s_sub_u32 s59, s59, 1
    s_cmp_eq_u32 s59, 0
    s_cbranch_scc1 gated_mix__mha_block__glu_gated_reglu__prompt_kernel_asy2_ok
    s_sleep 1
    s_branch gated_mix__mha_block__glu_gated_reglu__prompt_kernel_asy2
gated_mix__mha_block__glu_gated_reglu__prompt_kernel_asy2_ok:
    s_cmp_eq_u32 s57, 3
    s_cbranch_scc1 gated_mix__mha_block__glu_gated_reglu__prompt_kernel_kvd2_1_nd
    s_lshl_b32 s48, s57, 2
    s_add_u32 s48, s48, 21
    s_and_b32 s48, s48, 15
    s_lshl_b32 s48, s48, 12
    s_add_u32 m0, s56, 8192
    s_add_u32 s3, s55, s48
    buffer_load_dwordx4 v8, s[40:43], s3 offen lds
gated_mix__mha_block__glu_gated_reglu__prompt_kernel_kvd2_1_nd:
    v_mfma_f32_32x32x16_bf16 v[48:63], v[20:23], v[16:19], 0
    ds_read_b128 v[20:23], v9 offset:24576
    v_exp_f32 v32, v32
    v_exp_f32 v33, v33
    v_exp_f32 v34, v34
    v_exp_f32 v35, v35
    v_cvt_pk_bf16_f32 v64, v32, v33
    v_exp_f32 v36, v36
    v_cvt_pk_bf16_f32 v65, v34, v35
    v_exp_f32 v37, v37
    s_waitcnt lgkmcnt(1)
    v_mfma_f32_32x32x16_bf16 v[72:87], v[28:31], v[68:71], v[72:87]
    v_exp_f32 v38, v38
    v_exp_f32 v39, v39
    v_cvt_pk_bf16_f32 v66, v36, v37
    v_exp_f32 v40, v40
    v_cvt_pk_bf16_f32 v67, v38, v39
    v_exp_f32 v41, v41
    v_exp_f32 v42, v42
    v_exp_f32 v43, v43
    v_mfma_f32_32x32x16_bf16 v[72:87], v[24:27], v[64:67], v[72:87]
    s_mov_b64 exec, s[62:63]
    ds_read_b128 v[24:27], v10 offset:19456
    ds_read_b128 v[28:31], v10 offset:18944
    s_mov_b64 exec, -1
    v_cvt_pk_bf16_f32 v68, v40, v41
    v_exp_f32 v44, v44
    v_exp_f32 v45, v45
    v_cvt_pk_bf16_f32 v69, v42, v43
    v_exp_f32 v46, v46
    v_exp_f32 v47, v47
    v_cvt_pk_bf16_f32 v70, v44, v45
    v_cvt_pk_bf16_f32 v71, v46, v47
    s_waitcnt lgkmcnt(2)
    v_mfma_f32_32x32x16_bf16 v[32:47], v[20:23], v[16:19], 0
    ds_read_b128 v[20:23], v9 offset:25600
    v_exp_f32 v48, v48
    v_exp_f32 v49, v49
    v_exp_f32 v50, v50
    v_exp_f32 v51, v51
    v_cvt_pk_bf16_f32 v64, v48, v49
    v_exp_f32 v52, v52
    v_cvt_pk_bf16_f32 v65, v50, v51
    v_exp_f32 v53, v53
    s_waitcnt lgkmcnt(1)
    v_mfma_f32_32x32x16_bf16 v[72:87], v[28:31], v[68:71], v[72:87]
    v_exp_f32 v54, v54
    v_exp_f32 v55, v55
    v_cvt_pk_bf16_f32 v66, v52, v53
    v_exp_f32 v56, v56
    v_cvt_pk_bf16_f32 v67, v54, v55
    v_exp_f32 v57, v57
    v_exp_f32 v58, v58
    v_exp_f32 v59, v59
    v_mfma_f32_32x32x16_bf16 v[72:87], v[24:27], v[64:67], v[72:87]
    s_mov_b64 exec, s[62:63]
    ds_read_b128 v[24:27], v10 offset:24576
    ds_read_b128 v[28:31], v10 offset:19968
    s_mov_b64 exec, -1
    v_cvt_pk_bf16_f32 v68, v56, v57
    v_exp_f32 v60, v60
    v_exp_f32 v61, v61
    v_cvt_pk_bf16_f32 v69, v58, v59
    v_exp_f32 v62, v62
    v_exp_f32 v63, v63
    v_cvt_pk_bf16_f32 v70, v60, v61
    v_cvt_pk_bf16_f32 v71, v62, v63
    s_waitcnt lgkmcnt(2)
    v_mfma_f32_32x32x16_bf16 v[48:63], v[20:23], v[16:19], 0
    ds_read_b128 v[20:23], v9 offset:26624
    v_exp_f32 v32, v32
    v_exp_f32 v33, v33
    v_exp_f32 v34, v34
    v_exp_f32 v35, v35
    v_cvt_pk_bf16_f32 v64, v32, v33
    v_exp_f32 v36, v36
    v_cvt_pk_bf16_f32 v65, v34, v35
    v_exp_f32 v37, v37
    s_waitcnt lgkmcnt(1)
    v_mfma_f32_32x32x16_bf16 v[72:87], v[28:31], v[68:71], v[72:87]
    s_waitcnt vmcnt(1)
    s_mov_b64 exec, 1
    ds_add_u32 v12, v13 offset:12
    s_mov_b64 exec, -1
    v_exp_f32 v38, v38
    v_exp_f32 v39, v39
    v_cvt_pk_bf16_f32 v66, v36, v37
    v_exp_f32 v40, v40
    v_cvt_pk_bf16_f32 v67, v38, v39
    v_exp_f32 v41, v41
    v_exp_f32 v42, v42
    v_exp_f32 v43, v43
    v_mfma_f32_32x32x16_bf16 v[72:87], v[24:27], v[64:67], v[72:87]
    s_mov_b64 exec, s[62:63]
    ds_read_b128 v[24:27], v10 offset:25600
    ds_read_b128 v[28:31], v10 offset:25088
    s_mov_b64 exec, -1
    v_cvt_pk_bf16_f32 v68, v40, v41
    v_exp_f32 v44, v44
    v_exp_f32 v45, v45
    v_cvt_pk_bf16_f32 v69, v42, v43
    v_exp_f32 v46, v46
    v_exp_f32 v47, v47
    v_cvt_pk_bf16_f32 v70, v44, v45
    v_cvt_pk_bf16_f32 v71, v46, v47
    s_waitcnt lgkmcnt(3)
    v_mfma_f32_32x32x16_bf16 v[32:47], v[20:23], v[16:19], 0
    ds_read_b128 v[20:23], v9 offset:27648
    v_exp_f32 v48, v48
    v_exp_f32 v49, v49
    v_exp_f32 v50, v50
    v_exp_f32 v51, v51
    v_cvt_pk_bf16_f32 v64, v48, v49
    v_exp_f32 v52, v52
    v_cvt_pk_bf16_f32 v65, v50, v51
    v_exp_f32 v53, v53
    s_waitcnt lgkmcnt(1)
    v_mfma_f32_32x32x16_bf16 v[72:87], v[28:31], v[68:71], v[72:87]
    ds_read_b32 v14, v12 offset:12
    v_exp_f32 v54, v54
    v_exp_f32 v55, v55
    v_cvt_pk_bf16_f32 v66, v52, v53
    v_exp_f32 v56, v56
    v_cvt_pk_bf16_f32 v67, v54, v55
    v_exp_f32 v57, v57
    v_exp_f32 v58, v58
    v_exp_f32 v59, v59
    v_mfma_f32_32x32x16_bf16 v[72:87], v[24:27], v[64:67], v[72:87]
    s_mov_b64 exec, s[62:63]
    ds_read_b128 v[24:27], v10 offset:26624
    ds_read_b128 v[28:31], v10 offset:26112
    s_mov_b64 exec, -1
    v_cvt_pk_bf16_f32 v68, v56, v57
    v_exp_f32 v60, v60
    v_exp_f32 v61, v61
    v_cvt_pk_bf16_f32 v69, v58, v59
    v_exp_f32 v62, v62
    v_exp_f32 v63, v63
    v_cvt_pk_bf16_f32 v70, v60, v61
    v_cvt_pk_bf16_f32 v71, v62, v63
    s_waitcnt lgkmcnt(2)
    v_readfirstlane_b32 s60, v14
    s_cmp_ge_u32 s60, 8
    s_cbranch_scc1 gated_mix__mha_block__glu_gated_reglu__prompt_kernel_asy3_ok
    s_mov_b32 s59, 1600000
gated_mix__mha_block__glu_gated_reglu__prompt_kernel_asy3:
    ds_read_b32 v14, v12 offset:12
    s_waitcnt lgkmcnt(0)
    v_readfirstlane_b32 s60, v14
    s_cmp_ge_u32 s60, 8
    s_cbranch_scc1 gated_mix__mha_block__glu_gated_reglu__prompt_kernel_asy3_ok
    s_sub_u32 s59, s59, 1
    s_cmp_eq_u32 s59, 0
    s_cbranch_scc1 gated_mix__mha_block__glu_gated_reglu__prompt_kernel_asy3_ok
    s_sleep 1
    s_branch gated_mix__mha_block__glu_gated_reglu__prompt_kernel_asy3
gated_mix__mha_block__glu_gated_reglu__prompt_kernel_asy3_ok:
    s_cmp_eq_u32 s57, 3
    s_cbranch_scc1 gated_mix__mha_block__glu_gated_reglu__prompt_kernel_kvd3_1_nd
    s_lshl_b32 s48, s57, 2
    s_add_u32 s48, s48, 22
    s_and_b32 s48, s48, 15
    s_lshl_b32 s48, s48, 12
    s_add_u32 m0, s56, 16384
    s_add_u32 s3, s55, s48
    buffer_load_dwordx4 v8, s[40:43], s3 offen lds
gated_mix__mha_block__glu_gated_reglu__prompt_kernel_kvd3_1_nd:
    v_mfma_f32_32x32x16_bf16 v[48:63], v[20:23], v[16:19], 0
    ds_read_b128 v[20:23], v9 offset:0
    v_exp_f32 v32, v32
    v_exp_f32 v33, v33
    v_exp_f32 v34, v34
    v_exp_f32 v35, v35
    v_cvt_pk_bf16_f32 v64, v32, v33
    v_exp_f32 v36, v36
    v_cvt_pk_bf16_f32 v65, v34, v35
    v_exp_f32 v37, v37
    s_waitcnt lgkmcnt(1)
    v_mfma_f32_32x32x16_bf16 v[72:87], v[28:31], v[68:71], v[72:87]
    v_exp_f32 v38, v38
    v_exp_f32 v39, v39
    v_cvt_pk_bf16_f32 v66, v36, v37
    v_exp_f32 v40, v40
    v_cvt_pk_bf16_f32 v67, v38, v39
    v_exp_f32 v41, v41
    v_exp_f32 v42, v42
    v_exp_f32 v43, v43
    v_mfma_f32_32x32x16_bf16 v[72:87], v[24:27], v[64:67], v[72:87]
    s_mov_b64 exec, s[62:63]
    ds_read_b128 v[24:27], v10 offset:27648
    ds_read_b128 v[28:31], v10 offset:27136
    s_mov_b64 exec, -1
    v_cvt_pk_bf16_f32 v68, v40, v41
    v_exp_f32 v44, v44
    v_exp_f32 v45, v45
    v_cvt_pk_bf16_f32 v69, v42, v43
    v_exp_f32 v46, v46
    v_exp_f32 v47, v47
    v_cvt_pk_bf16_f32 v70, v44, v45
    v_cvt_pk_bf16_f32 v71, v46, v47
    s_waitcnt lgkmcnt(2)
    v_mfma_f32_32x32x16_bf16 v[32:47], v[20:23], v[16:19], 0
    ds_read_b128 v[20:23], v9 offset:1024
    v_exp_f32 v48, v48
    v_exp_f32 v49, v49
    v_exp_f32 v50, v50
    v_exp_f32 v51, v51
    v_cvt_pk_bf16_f32 v64, v48, v49
    v_exp_f32 v52, v52
    v_cvt_pk_bf16_f32 v65, v50, v51
    v_exp_f32 v53, v53
    s_waitcnt lgkmcnt(1)
    v_mfma_f32_32x32x16_bf16 v[72:87], v[28:31], v[68:71], v[72:87]
    v_exp_f32 v54, v54
    v_exp_f32 v55, v55
    v_cvt_pk_bf16_f32 v66, v52, v53
    v_exp_f32 v56, v56
    v_cvt_pk_bf16_f32 v67, v54, v55
    v_exp_f32 v57, v57
    v_exp_f32 v58, v58
    v_exp_f32 v59, v59
    v_mfma_f32_32x32x16_bf16 v[72:87], v[24:27], v[64:67], v[72:87]
    s_mov_b64 exec, s[62:63]
    ds_read_b128 v[24:27], v10 offset:0
    ds_read_b128 v[28:31], v10 offset:28160
    s_mov_b64 exec, -1
    v_cvt_pk_bf16_f32 v68, v56, v57
    v_exp_f32 v60, v60
    v_exp_f32 v61, v61
    v_cvt_pk_bf16_f32 v69, v58, v59
    v_exp_f32 v62, v62
    v_exp_f32 v63, v63
    v_cvt_pk_bf16_f32 v70, v60, v61
    v_cvt_pk_bf16_f32 v71, v62, v63
    v_add_u32 v12, 16, v12
    s_add_u32 s57, s57, 1
    s_cmp_lt_u32 s57, 4
    s_cbranch_scc1 gated_mix__mha_block__glu_gated_reglu__prompt_kernel_aloop
    s_setprio 3
    s_waitcnt lgkmcnt(0)
    v_mfma_f32_32x32x16_bf16 v[72:87], v[28:31], v[68:71], v[72:87]
    s_nop 11
    v_max3_f32 v2, abs(v72), abs(v73), abs(v74)
    v_max3_f32 v2, abs(v75), abs(v76), v2
    v_max3_f32 v2, abs(v77), abs(v78), v2
    v_max_f32 v2, abs(v79), v2
    s_mov_b32 s48, 0x7b800000
    v_cmp_nlt_f32 vcc, v2, s48
    s_mov_b32 s49, 0x5d800000
    s_mov_b32 s50, 0x21800000
    v_cmp_nlt_f32 s[64:65], v80, s49
    s_or_b64 vcc, vcc, s[64:65]
    v_cmp_ngt_f32 s[64:65], v80, s50
    s_or_b64 vcc, vcc, s[64:65]
    s_cbranch_vccnz gated_mix__mha_block__glu_gated_reglu__prompt_kernel_aslow
gated_mix__mha_block__glu_gated_reglu__prompt_kernel_anorm:
    v_rcp_f32 v2, v80
    s_nop 0
    v_mul_f32 v72, v2, v72
    v_mul_f32 v73, v2, v73
    v_mul_f32 v74, v2, v74
    v_mul_f32 v75, v2, v75
    v_mul_f32 v76, v2, v76
    v_mul_f32 v77, v2, v77
    v_mul_f32 v78, v2, v78
    v_mul_f32 v79, v2, v79
    v_cvt_pk_bf16_f32 v64, v72, v73
    v_cvt_pk_bf16_f32 v65, v74, v75
    v_cvt_pk_bf16_f32 v66, v76, v77
    v_cvt_pk_bf16_f32 v67, v78, v79
    s_lshl_b32 s48, s58, 15
    s_lshr_b32 s49, s54, 6
    s_add_u32 s48, s48, s49
    s_add_u32 s48, s48, 6291456
    buffer_store_dwordx4 v[64:67], v8, s[40:43], s48 offen sc1
    s_lshr_b32 s49, s54, 4
    s_lshl_b32 s50, s58, 6
    s_add_u32 s49, s49, s50
    s_add_u32 s49, s49, 8650752
    s_waitcnt vmcnt(0)
    v_mov_b32 v2, 0
    v_mov_b32 v3, s7
    s_mov_b64 exec, 1
    buffer_store_dword v3, v2, s[40:43], s49 offen sc1
    s_mov_b64 exec, -1
    s_barrier
    s_lshl_b32 s48, s6, 3
    s_and_b32 s49, s48, 31
    s_lshl_b32 s49, s49, 12
    s_lshr_b32 s50, s6, 2
    s_lshl_b32 s60, s52, 1
    s_add_u32 s50, s50, s60
    s_lshl_b32 s50, s50, 6
    s_add_u32 s49, s49, s50
    s_add_u32 s49, s49, 8650752
    v_lshlrev_b32 v2, 12, v1
    s_mov_b32 exec_lo, 0xff
    s_mov_b32 exec_hi, 0x0
    s_mov_b32 s59, 200000
gated_mix__mha_block__glu_gated_reglu__prompt_kernel_a_pollo:
    buffer_load_dword v3, v2, s[40:43], s49 offen sc1
    s_waitcnt vmcnt(0)
    v_cmp_ne_u32 vcc, s7, v3
    s_cbranch_vccz gated_mix__mha_block__glu_gated_reglu__prompt_kernel_a_pollo_ok
    s_sub_u32 s59, s59, 1
    s_cmp_eq_u32 s59, 0
    s_cbranch_scc1 gated_mix__mha_block__glu_gated_reglu__prompt_kernel_a_pollo_ok
    s_sleep 1
    s_branch gated_mix__mha_block__glu_gated_reglu__prompt_kernel_a_pollo
gated_mix__mha_block__glu_gated_reglu__prompt_kernel_a_pollo_ok:
    s_mov_b64 exec, -1
    s_lshl_b32 s48, s6, 13
    s_lshl_b32 s49, s52, 16
    s_add_u32 s49, s49, s48
    s_add_u32 s49, s49, 6291456
    s_add_u32 s50, s48, 65536
    s_add_u32 m0, s50, 0
    s_add_u32 s3, s49, 0
    buffer_load_dwordx4 v8, s[40:43], s3 offen lds
    s_add_u32 m0, s50, 1024
    s_add_u32 s3, s49, 1024
    buffer_load_dwordx4 v8, s[40:43], s3 offen lds
    s_add_u32 m0, s50, 2048
    s_add_u32 s3, s49, 2048
    buffer_load_dwordx4 v8, s[40:43], s3 offen lds
    s_add_u32 m0, s50, 3072
    s_add_u32 s3, s49, 3072
    buffer_load_dwordx4 v8, s[40:43], s3 offen lds
    s_add_u32 m0, s50, 4096
    s_add_u32 s3, s49, 4096
    buffer_load_dwordx4 v8, s[40:43], s3 offen lds
    s_add_u32 m0, s50, 5120
    s_add_u32 s3, s49, 5120
    buffer_load_dwordx4 v8, s[40:43], s3 offen lds
    s_add_u32 m0, s50, 6144
    s_add_u32 s3, s49, 6144
    buffer_load_dwordx4 v8, s[40:43], s3 offen lds
    s_add_u32 m0, s50, 7168
    s_add_u32 s3, s49, 7168
    buffer_load_dwordx4 v8, s[40:43], s3 offen lds
    s_waitcnt vmcnt(0)
    s_barrier
    s_branch gated_mix__mha_block__glu_gated_reglu__prompt_kernel_fin
gated_mix__mha_block__glu_gated_reglu__prompt_kernel_aslow:
    v_mov_b32 v2, 0xff800000
    s_add_u32 s49, s54, 2097152
    s_mov_b32 s57, 0
gated_mix__mha_block__glu_gated_reglu__prompt_kernel_aslow1:
    buffer_load_dwordx4 v[20:23], v8, s[40:43], s49 offen
    s_waitcnt vmcnt(0)
    v_mfma_f32_32x32x16_bf16 v[32:47], v[20:23], v[16:19], 0
    s_nop 11
    v_max3_f32 v2, v32, v33, v2
    v_max3_f32 v2, v34, v35, v2
    v_max3_f32 v2, v36, v37, v2
    v_max3_f32 v2, v38, v39, v2
    v_max3_f32 v2, v40, v41, v2
    v_max3_f32 v2, v42, v43, v2
    v_max3_f32 v2, v44, v45, v2
    v_max3_f32 v2, v46, v47, v2
    s_add_u32 s49, s49, 1024
    s_add_u32 s57, s57, 1
    s_cmp_lt_u32 s57, 64
    s_cbranch_scc1 gated_mix__mha_block__glu_gated_reglu__prompt_kernel_aslow1
    v_mov_b32 v3, v2
    s_nop 1
    v_permlane32_swap_b32 v2, v3
    s_nop 1
    v_max_f32 v2, v2, v3
    v_sub_f32 v88, 0, v2
    v_sub_f32 v89, 0, v2
    v_sub_f32 v90, 0, v2
    v_sub_f32 v91, 0, v2
    v_sub_f32 v92, 0, v2
    v_sub_f32 v93, 0, v2
    v_sub_f32 v94, 0, v2
    v_sub_f32 v95, 0, v2
    v_sub_f32 v96, 0, v2
    v_sub_f32 v97, 0, v2
    v_sub_f32 v98, 0, v2
    v_sub_f32 v99, 0, v2
    v_sub_f32 v100, 0, v2
    v_sub_f32 v101, 0, v2
    v_sub_f32 v102, 0, v2
    v_sub_f32 v103, 0, v2
    v_mov_b32 v72, 0
    v_mov_b32 v73, 0
    v_mov_b32 v74, 0
    v_mov_b32 v75, 0
    v_mov_b32 v76, 0
    v_mov_b32 v77, 0
    v_mov_b32 v78, 0
    v_mov_b32 v79, 0
    v_mov_b32 v80, 0
    v_mov_b32 v81, 0
    v_mov_b32 v82, 0
    v_mov_b32 v83, 0
    v_mov_b32 v84, 0
    v_mov_b32 v85, 0
    v_mov_b32 v86, 0
    v_mov_b32 v87, 0
    s_add_u32 s49, s54, 2097152
    s_add_u32 s50, s54, 4194304
    s_mov_b32 s57, 0
gated_mix__mha_block__glu_gated_reglu__prompt_kernel_aslow2:
    buffer_load_dwordx4 v[20:23], v8, s[40:43], s49 offen
    s_mov_b64 exec, s[62:63]
    buffer_load_dwordx4 v[24:27], v11, s[40:43], s50 offen
    buffer_load_dwordx4 v[28:31], v11, s[40:43], s50 offen offset:512
    s_mov_b64 exec, -1
    s_waitcnt vmcnt(0)
    v_mfma_f32_32x32x16_bf16 v[32:47], v[20:23], v[16:19], v[88:103]
    s_nop 11
    v_exp_f32 v32, v32
    v_exp_f32 v33, v33
    v_exp_f32 v34, v34
    v_exp_f32 v35, v35
    v_exp_f32 v36, v36
    v_exp_f32 v37, v37
    v_exp_f32 v38, v38
    v_exp_f32 v39, v39
    v_exp_f32 v40, v40
    v_exp_f32 v41, v41
    v_exp_f32 v42, v42
    v_exp_f32 v43, v43
    v_exp_f32 v44, v44
    v_exp_f32 v45, v45
    v_exp_f32 v46, v46
    v_exp_f32 v47, v47
    s_nop 0
    v_cvt_pk_bf16_f32 v64, v32, v33
    v_cvt_pk_bf16_f32 v65, v34, v35
    v_cvt_pk_bf16_f32 v66, v36, v37
    v_cvt_pk_bf16_f32 v67, v38, v39
    v_cvt_pk_bf16_f32 v68, v40, v41
    v_cvt_pk_bf16_f32 v69, v42, v43
    v_cvt_pk_bf16_f32 v70, v44, v45
    v_cvt_pk_bf16_f32 v71, v46, v47
    s_nop 1
    v_mfma_f32_32x32x16_bf16 v[72:87], v[24:27], v[64:67], v[72:87]
    v_mfma_f32_32x32x16_bf16 v[72:87], v[28:31], v[68:71], v[72:87]
    s_add_u32 s49, s49, 1024
    s_add_u32 s50, s50, 1024
    s_add_u32 s57, s57, 1
    s_cmp_lt_u32 s57, 64
    s_cbranch_scc1 gated_mix__mha_block__glu_gated_reglu__prompt_kernel_aslow2
    s_nop 11
    s_branch gated_mix__mha_block__glu_gated_reglu__prompt_kernel_anorm
gated_mix__mha_block__glu_gated_reglu__prompt_kernel_g:
    s_sub_u32 s54, s6, 4
    v_lshrrev_b32 v2, 2, v1
    v_and_b32 v2, 4, v2
    v_and_b32 v3, 7, v1
    v_xor_b32 v2, v2, v3
    v_lshlrev_b32 v2, 4, v2
    v_lshrrev_b32 v3, 3, v1
    v_mul_u32_u24 v3, 3072, v3
    v_add_u32 v7, v2, v3
    s_mul_i32 s48, s54, 3
    s_add_u32 s48, s48, 0
    s_and_b32 s49, s48, 7
    s_mul_i32 s49, s49, 24576
    s_lshr_b32 s48, s48, 3
    s_lshl_b32 s48, s48, 10
    s_add_u32 s58, s49, s48
    s_lshl_b32 s48, s5, 7
    s_add_u32 s58, s58, s48
    s_mul_i32 s48, s54, 3
    s_add_u32 s48, s48, 1
    s_and_b32 s49, s48, 7
    s_mul_i32 s49, s49, 24576
    s_lshr_b32 s48, s48, 3
    s_lshl_b32 s48, s48, 10
    s_add_u32 s59, s49, s48
    s_lshl_b32 s48, s5, 7
    s_add_u32 s59, s59, s48
    s_mul_i32 s48, s54, 3
    s_add_u32 s48, s48, 2
    s_and_b32 s49, s48, 7
    s_mul_i32 s49, s49, 24576
    s_lshr_b32 s48, s48, 3
    s_lshl_b32 s48, s48, 10
    s_add_u32 s60, s49, s48
    s_lshl_b32 s48, s5, 7
    s_add_u32 s60, s60, s48
    s_mul_i32 s57, s54, 3072
    s_add_u32 s57, s57, 65536
    s_and_b32 s48, s54, 1
    s_lshl_b32 s48, s48, 2
    v_lshrrev_b32 v2, 4, v1
    v_add_u32 v2, s48, v2
    v_and_b32 v3, 7, v1
    v_xor_b32 v2, v2, v3
    v_lshlrev_b32 v2, 4, v2
    v_lshrrev_b32 v3, 3, v1
    v_lshlrev_b32 v3, 10, v3
    v_add_u32 v6, v2, v3
    s_lshl_b32 s55, s4, 16
    s_lshl_b32 s48, s54, 13
    s_add_u32 s55, s55, s48
    s_lshl_b32 s56, s54, 10
    v_mov_b32 v9, 0
    s_waitcnt lgkmcnt(0)
    s_mov_b32 s12, s10
    s_mov_b32 s13, s11
    s_mov_b32 s10, 2097152
    s_mov_b32 s11, 0x20000
    s_mov_b32 s14, 1572864
    s_mov_b32 s15, 0x20000
    s_add_u32 s48, s4, 0
    s_and_b32 s48, s48, 7
    s_lshl_b32 s61, s48, 7
    s_add_u32 s61, s61, s55
    s_lshl_b32 s62, s48, 13
    s_add_u32 s62, s62, s56
    s_mul_i32 s63, s48, 196608
    s_mov_b32 m0, s62
    s_nop 0
    buffer_load_dwordx4 v6, s[8:11], s61 offen lds
    s_add_u32 s48, s4, 0
    s_and_b32 s48, s48, 7
    s_lshl_b32 s61, s48, 7
    s_add_u32 s61, s61, s55
    s_lshl_b32 s62, s48, 13
    s_add_u32 s62, s62, s56
    s_mul_i32 s63, s48, 196608
    s_add_u32 m0, s57, 0
    s_add_u32 s3, s58, s63
    buffer_load_dwordx4 v7, s[12:15], s3 offen lds
    s_add_u32 m0, s57, 1024
    s_add_u32 s3, s59, s63
    buffer_load_dwordx4 v7, s[12:15], s3 offen lds
    s_add_u32 m0, s57, 2048
    s_add_u32 s3, s60, s63
    buffer_load_dwordx4 v7, s[12:15], s3 offen lds
    s_mov_b32 s24, s22
    s_mov_b32 s25, s23
    s_mov_b32 s32, s30
    s_mov_b32 s33, s31
    s_mov_b32 s44, s38
    s_mov_b32 s45, s39
    s_mov_b32 s18, 524288
    s_mov_b32 s19, 0x20000
    s_mov_b32 s22, 1835008
    s_mov_b32 s23, 0x20000
    s_mov_b32 s26, 1835008
    s_mov_b32 s27, 0x20000
    s_mov_b32 s30, 1835008
    s_mov_b32 s31, 0x20000
    s_mov_b32 s34, 1024
    s_mov_b32 s35, 0x20000
    s_mov_b32 s38, 2097152
    s_mov_b32 s39, 0x20000
    s_mov_b32 s42, 25165824
    s_mov_b32 s43, 0x20000
    s_mov_b32 s46, 256
    s_mov_b32 s47, 0x20000
    s_barrier
    s_add_u32 s48, s4, 1
    s_and_b32 s48, s48, 7
    s_lshl_b32 s61, s48, 7
    s_add_u32 s61, s61, s55
    s_lshl_b32 s62, s48, 13
    s_add_u32 s62, s62, s56
    s_mul_i32 s63, s48, 196608
    s_mov_b32 m0, s62
    s_nop 0
    buffer_load_dwordx4 v6, s[8:11], s61 offen lds
    s_add_u32 s48, s4, 1
    s_and_b32 s48, s48, 7
    s_lshl_b32 s61, s48, 7
    s_add_u32 s61, s61, s55
    s_lshl_b32 s62, s48, 13
    s_add_u32 s62, s62, s56
    s_mul_i32 s63, s48, 196608
    s_add_u32 m0, s57, 24576
    s_add_u32 s3, s58, s63
    buffer_load_dwordx4 v7, s[12:15], s3 offen lds
    s_add_u32 m0, s57, 25600
    s_add_u32 s3, s59, s63
    buffer_load_dwordx4 v7, s[12:15], s3 offen lds
    s_add_u32 m0, s57, 26624
    s_add_u32 s3, s60, s63
    buffer_load_dwordx4 v7, s[12:15], s3 offen lds
    s_add_u32 s48, s4, 2
    s_and_b32 s48, s48, 7
    s_lshl_b32 s61, s48, 7
    s_add_u32 s61, s61, s55
    s_lshl_b32 s62, s48, 13
    s_add_u32 s62, s62, s56
    s_mul_i32 s63, s48, 196608
    s_mov_b32 m0, s62
    s_nop 0
    buffer_load_dwordx4 v6, s[8:11], s61 offen lds
    s_add_u32 s48, s4, 2
    s_and_b32 s48, s48, 7
    s_lshl_b32 s61, s48, 7
    s_add_u32 s61, s61, s55
    s_lshl_b32 s62, s48, 13
    s_add_u32 s62, s62, s56
    s_mul_i32 s63, s48, 196608
    s_add_u32 m0, s57, 49152
    s_add_u32 s3, s58, s63
    buffer_load_dwordx4 v7, s[12:15], s3 offen lds
    s_add_u32 m0, s57, 50176
    s_add_u32 s3, s59, s63
    buffer_load_dwordx4 v7, s[12:15], s3 offen lds
    s_add_u32 m0, s57, 51200
    s_add_u32 s3, s60, s63
    buffer_load_dwordx4 v7, s[12:15], s3 offen lds
    s_add_u32 s48, s4, 3
    s_and_b32 s48, s48, 7
    s_lshl_b32 s61, s48, 7
    s_add_u32 s61, s61, s55
    s_lshl_b32 s62, s48, 13
    s_add_u32 s62, s62, s56
    s_mul_i32 s63, s48, 196608
    s_mov_b32 m0, s62
    s_nop 0
    buffer_load_dwordx4 v6, s[8:11], s61 offen lds
    s_add_u32 s48, s4, 4
    s_and_b32 s48, s48, 7
    s_lshl_b32 s61, s48, 7
    s_add_u32 s61, s61, s55
    s_lshl_b32 s62, s48, 13
    s_add_u32 s62, s62, s56
    s_mul_i32 s63, s48, 196608
    s_mov_b32 m0, s62
    s_nop 0
    buffer_load_dwordx4 v6, s[8:11], s61 offen lds
    s_add_u32 s48, s4, 5
    s_and_b32 s48, s48, 7
    s_lshl_b32 s61, s48, 7
    s_add_u32 s61, s61, s55
    s_lshl_b32 s62, s48, 13
    s_add_u32 s62, s62, s56
    s_mul_i32 s63, s48, 196608
    s_mov_b32 m0, s62
    s_nop 0
    buffer_load_dwordx4 v6, s[8:11], s61 offen lds
    s_add_u32 s48, s4, 6
    s_and_b32 s48, s48, 7
    s_lshl_b32 s61, s48, 7
    s_add_u32 s61, s61, s55
    s_lshl_b32 s62, s48, 13
    s_add_u32 s62, s62, s56
    s_mul_i32 s63, s48, 196608
    s_mov_b32 m0, s62
    s_nop 0
    buffer_load_dwordx4 v6, s[8:11], s61 offen lds
    s_add_u32 s48, s4, 7
    s_and_b32 s48, s48, 7
    s_lshl_b32 s61, s48, 7
    s_add_u32 s61, s61, s55
    s_lshl_b32 s62, s48, 13
    s_add_u32 s62, s62, s56
    s_mul_i32 s63, s48, 196608
    s_mov_b32 m0, s62
    s_nop 0
    buffer_load_dwordx4 v6, s[8:11], s61 offen lds
    s_waitcnt vmcnt(13)
    s_barrier
    s_waitcnt vmcnt(9)
    s_barrier
    s_add_u32 s48, s4, 3
    s_and_b32 s48, s48, 7
    s_lshl_b32 s61, s48, 7
    s_add_u32 s61, s61, s55
    s_lshl_b32 s62, s48, 13
    s_add_u32 s62, s62, s56
    s_mul_i32 s63, s48, 196608
    s_add_u32 m0, s57, 0
    s_add_u32 s3, s58, s63
    buffer_load_dwordx4 v7, s[12:15], s3 offen lds
    s_add_u32 m0, s57, 1024
    s_add_u32 s3, s59, s63
    buffer_load_dwordx4 v7, s[12:15], s3 offen lds
    s_add_u32 m0, s57, 2048
    s_add_u32 s3, s60, s63
    buffer_load_dwordx4 v7, s[12:15], s3 offen lds
    s_waitcnt vmcnt(8)
    s_barrier
    s_add_u32 s48, s4, 4
    s_and_b32 s48, s48, 7
    s_lshl_b32 s61, s48, 7
    s_add_u32 s61, s61, s55
    s_lshl_b32 s62, s48, 13
    s_add_u32 s62, s62, s56
    s_mul_i32 s63, s48, 196608
    s_add_u32 m0, s57, 24576
    s_add_u32 s3, s58, s63
    buffer_load_dwordx4 v7, s[12:15], s3 offen lds
    s_add_u32 m0, s57, 25600
    s_add_u32 s3, s59, s63
    buffer_load_dwordx4 v7, s[12:15], s3 offen lds
    s_add_u32 m0, s57, 26624
    s_add_u32 s3, s60, s63
    buffer_load_dwordx4 v7, s[12:15], s3 offen lds
    s_waitcnt vmcnt(3)
    s_barrier
    s_add_u32 s48, s4, 5
    s_and_b32 s48, s48, 7
    s_lshl_b32 s61, s48, 7
    s_add_u32 s61, s61, s55
    s_lshl_b32 s62, s48, 13
    s_add_u32 s62, s62, s56
    s_mul_i32 s63, s48, 196608
    s_add_u32 m0, s57, 49152
    s_add_u32 s3, s58, s63
    buffer_load_dwordx4 v7, s[12:15], s3 offen lds
    s_add_u32 m0, s57, 50176
    s_add_u32 s3, s59, s63
    buffer_load_dwordx4 v7, s[12:15], s3 offen lds
    s_add_u32 m0, s57, 51200
    s_add_u32 s3, s60, s63
    buffer_load_dwordx4 v7, s[12:15], s3 offen lds
    s_waitcnt vmcnt(3)
    s_barrier
    s_add_u32 s48, s4, 6
    s_and_b32 s48, s48, 7
    s_lshl_b32 s61, s48, 7
    s_add_u32 s61, s61, s55
    s_lshl_b32 s62, s48, 13
    s_add_u32 s62, s62, s56
    s_mul_i32 s63, s48, 196608
    s_add_u32 m0, s57, 0
    s_add_u32 s3, s58, s63
    buffer_load_dwordx4 v7, s[12:15], s3 offen lds
    s_add_u32 m0, s57, 1024
    s_add_u32 s3, s59, s63
    buffer_load_dwordx4 v7, s[12:15], s3 offen lds
    s_add_u32 m0, s57, 2048
    s_add_u32 s3, s60, s63
    buffer_load_dwordx4 v7, s[12:15], s3 offen lds
    s_waitcnt vmcnt(3)
    s_barrier
    s_add_u32 s48, s4, 7
    s_and_b32 s48, s48, 7
    s_lshl_b32 s61, s48, 7
    s_add_u32 s61, s61, s55
    s_lshl_b32 s62, s48, 13
    s_add_u32 s62, s62, s56
    s_mul_i32 s63, s48, 196608
    s_add_u32 m0, s57, 24576
    s_add_u32 s3, s58, s63
    buffer_load_dwordx4 v7, s[12:15], s3 offen lds
    s_add_u32 m0, s57, 25600
    s_add_u32 s3, s59, s63
    buffer_load_dwordx4 v7, s[12:15], s3 offen lds
    s_add_u32 m0, s57, 26624
    s_add_u32 s3, s60, s63
    buffer_load_dwordx4 v7, s[12:15], s3 offen lds
    buffer_load_dword v8, v9, s[44:47], 0 offen sc1
    s_waitcnt vmcnt(4)
    s_barrier
    s_waitcnt vmcnt(1)
    s_barrier
    s_waitcnt vmcnt(0)
    v_readfirstlane_b32 s7, v8
    s_mov_b32 s49, 200000
gated_mix__mha_block__glu_gated_reglu__prompt_kernel_LG_tag:
    s_cmp_lg_u32 s7, 0
    s_cbranch_scc1 gated_mix__mha_block__glu_gated_reglu__prompt_kernel_LG_tagok
    buffer_load_dword v8, v9, s[44:47], 0 offen sc1
    s_waitcnt vmcnt(0)
    v_readfirstlane_b32 s7, v8
    s_sub_u32 s49, s49, 1
    s_cmp_lg_u32 s49, 0
    s_cbranch_scc1 gated_mix__mha_block__glu_gated_reglu__prompt_kernel_LG_tag
gated_mix__mha_block__glu_gated_reglu__prompt_kernel_LG_tagok:
    s_barrier
    s_and_b32 s48, s4, 3
    s_lshl_b32 s48, s48, 1
    s_lshr_b32 s3, s4, 2
    s_and_b32 s3, s3, 1
    s_add_u32 s48, s48, s3
    s_cmp_eq_u32 s5, s48
    s_cbranch_scc1 gated_mix__mha_block__glu_gated_reglu__prompt_kernel_gate
    s_and_b32 s48, s4, 3
    s_lshl_b32 s48, s48, 1
    s_lshr_b32 s3, s4, 2
    s_and_b32 s3, s3, 1
    s_add_u32 s48, s48, s3
    s_cmp_gt_u32 s5, s48
    s_cselect_b32 s48, 1, 0
    s_sub_u32 s58, s5, s48
    s_setprio 1
    s_sub_u32 s54, s6, 8
    v_mov_b32 v162, 155648
    s_mov_b32 s49, 1600000
gated_mix__mha_block__glu_gated_reglu__prompt_kernel_g_hold:
    ds_read_b32 v163, v162 offset:84
    s_waitcnt lgkmcnt(0)
    v_readfirstlane_b32 s48, v163
    s_cmp_ge_u32 s48, 8
    s_cbranch_scc1 gated_mix__mha_block__glu_gated_reglu__prompt_kernel_g_hold_ok
    s_sub_u32 s49, s49, 1
    s_cmp_eq_u32 s49, 0
    s_cbranch_scc1 gated_mix__mha_block__glu_gated_reglu__prompt_kernel_g_hold_ok
    s_sleep 1
    s_branch gated_mix__mha_block__glu_gated_reglu__prompt_kernel_g_hold
gated_mix__mha_block__glu_gated_reglu__prompt_kernel_g_hold_ok:
    v_lshrrev_b32 v162, 2, v1
    v_and_b32 v162, 4, v162
    v_and_b32 v163, 7, v1
    v_xor_b32 v162, v162, v163
    v_lshlrev_b32 v162, 4, v162
    v_lshrrev_b32 v163, 3, v1
    v_mul_u32_u24 v163, 3584, v163
    v_add_u32 v160, v162, v163
    s_lshl_b32 s55, s58, 9
    s_lshl_b32 s48, s54, 7
    s_add_u32 s55, s55, s48
    s_mul_i32 s56, s54, 12288
    s_add_u32 s56, s56, 65536
    s_add_u32 s48, s4, 0
    s_and_b32 s48, s48, 7
    s_mul_i32 s59, s48, 229376
    s_add_u32 s59, s59, s55
    s_add_u32 m0, s56, 0
    s_add_u32 s3, s59, 0
    buffer_load_dwordx4 v160, s[20:23], s3 offen lds
    s_add_u32 m0, s56, 1024
    s_add_u32 s3, s59, 28672
    buffer_load_dwordx4 v160, s[20:23], s3 offen lds
    s_add_u32 m0, s56, 2048
    s_add_u32 s3, s59, 0
    buffer_load_dwordx4 v160, s[24:27], s3 offen lds
    s_add_u32 m0, s56, 3072
    s_add_u32 s3, s59, 28672
    buffer_load_dwordx4 v160, s[24:27], s3 offen lds
    s_add_u32 m0, s56, 4096
    s_add_u32 s3, s59, 57344
    buffer_load_dwordx4 v160, s[20:23], s3 offen lds
    s_add_u32 m0, s56, 5120
    s_add_u32 s3, s59, 86016
    buffer_load_dwordx4 v160, s[20:23], s3 offen lds
    s_add_u32 m0, s56, 6144
    s_add_u32 s3, s59, 57344
    buffer_load_dwordx4 v160, s[24:27], s3 offen lds
    s_add_u32 m0, s56, 7168
    s_add_u32 s3, s59, 86016
    buffer_load_dwordx4 v160, s[24:27], s3 offen lds
    s_add_u32 m0, s56, 8192
    s_add_u32 s3, s59, 114688
    buffer_load_dwordx4 v160, s[20:23], s3 offen lds
    s_add_u32 m0, s56, 9216
    s_add_u32 s3, s59, 143360
    buffer_load_dwordx4 v160, s[20:23], s3 offen lds
    s_add_u32 m0, s56, 10240
    s_add_u32 s3, s59, 114688
    buffer_load_dwordx4 v160, s[24:27], s3 offen lds
    s_add_u32 m0, s56, 11264
    s_add_u32 s3, s59, 143360
    buffer_load_dwordx4 v160, s[24:27], s3 offen lds
    v_and_b32 v144, 31, v1
    v_lshrrev_b32 v145, 3, v144
    v_lshlrev_b32 v145, 10, v145
    v_and_b32 v146, 7, v144
    v_lshlrev_b32 v146, 7, v146
    v_add_u32 v145, v145, v146
    v_lshrrev_b32 v146, 1, v144
    v_and_b32 v146, 7, v146
    v_lshrrev_b32 v147, 5, v1
    v_xor_b32 v146, v146, v147
    v_lshlrev_b32 v146, 4, v146
    v_add_u32 v156, v145, v146
    v_and_b32 v162, 15, v1
    v_lshrrev_b32 v162, 2, v162
    v_lshlrev_b32 v158, 7, v162
    v_lshrrev_b32 v162, 1, v162
    v_lshlrev_b32 v162, 6, v162
    v_add_u32 v158, v158, v162
    v_lshlrev_b32 v162, 1, v1
    v_and_b32 v162, 32, v162
    v_add_u32 v158, v158, v162
    v_and_b32 v162, 3, v1
    v_lshlrev_b32 v162, 3, v162
    v_add_u32 v158, v158, v162
    v_lshrrev_b32 v162, 5, v1
    v_mul_u32_u24 v162, 1024, v162
    v_add_u32 v158, v158, v162
    v_add_u32 v158, s56, v158
    v_and_b32 v162, 15, v1
    v_lshrrev_b32 v162, 2, v162
    v_lshlrev_b32 v159, 7, v162
    v_lshrrev_b32 v162, 1, v162
    v_xor_b32 v162, 1, v162
    v_lshlrev_b32 v162, 6, v162
    v_add_u32 v159, v159, v162
    v_lshlrev_b32 v162, 1, v1
    v_and_b32 v162, 32, v162
    v_add_u32 v159, v159, v162
    v_and_b32 v162, 3, v1
    v_lshlrev_b32 v162, 3, v162
    v_add_u32 v159, v159, v162
    v_lshrrev_b32 v162, 5, v1
    v_mul_u32_u24 v162, 1024, v162
    v_add_u32 v159, v159, v162
    v_add_u32 v159, s56, v159
    s_setprio 0
    s_waitcnt vmcnt(8)
    s_add_u32 s61, s4, 0
    s_and_b32 s61, s61, 7
    s_lshl_b32 s61, s61, 13
    v_add_u32 v165, s61, v156
    ds_read_b128 v[132:135], v165 offset:0
    ds_read_b64_tr_b16 v[140:141], v158 offset:0
    ds_read_b64_tr_b16 v[142:143], v158 offset:512
    ds_read_b64_tr_b16 v[144:145], v158 offset:2048
    ds_read_b64_tr_b16 v[146:147], v158 offset:2560
    ds_read_b64_tr_b16 v[148:149], v159 offset:0
    ds_read_b64_tr_b16 v[150:151], v159 offset:512
    ds_read_b64_tr_b16 v[152:153], v159 offset:2048
    ds_read_b64_tr_b16 v[154:155], v159 offset:2560
    ds_read_b128 v[136:139], v165 offset:4096
    s_waitcnt lgkmcnt(7)
    v_mfma_f32_32x32x16_bf16 v[4:19], v[140:143], v[132:135], 0
    s_waitcnt lgkmcnt(5)
    s_setprio 1
    v_mfma_f32_32x32x16_bf16 v[20:35], v[144:147], v[132:135], 0
    s_setprio 0
    s_waitcnt lgkmcnt(3)
    v_mfma_f32_32x32x16_bf16 v[36:51], v[148:151], v[132:135], 0
    s_waitcnt lgkmcnt(1)
    s_setprio 1
    v_mfma_f32_32x32x16_bf16 v[52:67], v[152:155], v[132:135], 0
    s_setprio 0
    s_waitcnt vmcnt(4)
    v_xor_b32 v157, 32, v165
    ds_read_b128 v[132:135], v157 offset:0
    s_waitcnt lgkmcnt(1)
    v_mfma_f32_32x32x16_bf16 v[68:83], v[140:143], v[136:139], 0
    ds_read_b64_tr_b16 v[140:141], v158 offset:4096
    ds_read_b64_tr_b16 v[142:143], v158 offset:4608
    s_add_u32 m0, s56, 0
    s_add_u32 s3, s59, 172032
    buffer_load_dwordx4 v160, s[20:23], s3 offen lds
    s_setprio 1
    v_mfma_f32_32x32x16_bf16 v[84:99], v[144:147], v[136:139], 0
    s_setprio 0
    ds_read_b64_tr_b16 v[144:145], v158 offset:6144
    ds_read_b64_tr_b16 v[146:147], v158 offset:6656
    s_add_u32 m0, s56, 1024
    s_add_u32 s3, s59, 200704
    buffer_load_dwordx4 v160, s[20:23], s3 offen lds
    v_mfma_f32_32x32x16_bf16 v[100:115], v[148:151], v[136:139], 0
    ds_read_b64_tr_b16 v[148:149], v159 offset:4096
    ds_read_b64_tr_b16 v[150:151], v159 offset:4608
    s_add_u32 m0, s56, 2048
    s_add_u32 s3, s59, 172032
    buffer_load_dwordx4 v160, s[24:27], s3 offen lds
    s_setprio 1
    v_mfma_f32_32x32x16_bf16 v[116:131], v[152:155], v[136:139], 0
    s_setprio 0
    ds_read_b64_tr_b16 v[152:153], v159 offset:6144
    ds_read_b64_tr_b16 v[154:155], v159 offset:6656
    ds_read_b128 v[136:139], v157 offset:4096
    s_add_u32 m0, s56, 3072
    s_add_u32 s3, s59, 200704
    buffer_load_dwordx4 v160, s[24:27], s3 offen lds
    s_waitcnt lgkmcnt(7)
    v_mfma_f32_32x32x16_bf16 v[4:19], v[140:143], v[132:135], v[4:19]
    s_waitcnt lgkmcnt(5)
    s_setprio 1
    v_mfma_f32_32x32x16_bf16 v[20:35], v[144:147], v[132:135], v[20:35]
    s_setprio 0
    s_waitcnt lgkmcnt(3)
    v_mfma_f32_32x32x16_bf16 v[36:51], v[148:151], v[132:135], v[36:51]
    s_waitcnt lgkmcnt(1)
    s_setprio 1
    v_mfma_f32_32x32x16_bf16 v[52:67], v[152:155], v[132:135], v[52:67]
    s_setprio 0
    s_waitcnt vmcnt(4)
    v_xor_b32 v157, 64, v165
    ds_read_b128 v[132:135], v157 offset:0
    s_waitcnt lgkmcnt(1)
    v_mfma_f32_32x32x16_bf16 v[68:83], v[140:143], v[136:139], v[68:83]
    ds_read_b64_tr_b16 v[140:141], v158 offset:8192
    ds_read_b64_tr_b16 v[142:143], v158 offset:8704
    s_add_u32 s48, s4, 1
    s_and_b32 s48, s48, 7
    s_mul_i32 s60, s48, 229376
    s_add_u32 s60, s60, s55
    s_add_u32 m0, s56, 4096
    s_add_u32 s3, s60, 0
    buffer_load_dwordx4 v160, s[20:23], s3 offen lds
    s_setprio 1
    v_mfma_f32_32x32x16_bf16 v[84:99], v[144:147], v[136:139], v[84:99]
    s_setprio 0
    ds_read_b64_tr_b16 v[144:145], v158 offset:10240
    ds_read_b64_tr_b16 v[146:147], v158 offset:10752
    s_add_u32 m0, s56, 5120
    s_add_u32 s3, s60, 28672
    buffer_load_dwordx4 v160, s[20:23], s3 offen lds
    v_mfma_f32_32x32x16_bf16 v[100:115], v[148:151], v[136:139], v[100:115]
    ds_read_b64_tr_b16 v[148:149], v159 offset:8192
    ds_read_b64_tr_b16 v[150:151], v159 offset:8704
    s_add_u32 m0, s56, 6144
    s_add_u32 s3, s60, 0
    buffer_load_dwordx4 v160, s[24:27], s3 offen lds
    s_setprio 1
    v_mfma_f32_32x32x16_bf16 v[116:131], v[152:155], v[136:139], v[116:131]
    s_setprio 0
    ds_read_b64_tr_b16 v[152:153], v159 offset:10240
    ds_read_b64_tr_b16 v[154:155], v159 offset:10752
    ds_read_b128 v[136:139], v157 offset:4096
    s_add_u32 m0, s56, 7168
    s_add_u32 s3, s60, 28672
    buffer_load_dwordx4 v160, s[24:27], s3 offen lds
    s_waitcnt lgkmcnt(7)
    v_mfma_f32_32x32x16_bf16 v[4:19], v[140:143], v[132:135], v[4:19]
    s_waitcnt lgkmcnt(5)
    s_setprio 1
    v_mfma_f32_32x32x16_bf16 v[20:35], v[144:147], v[132:135], v[20:35]
    s_setprio 0
    s_waitcnt lgkmcnt(3)
    v_mfma_f32_32x32x16_bf16 v[36:51], v[148:151], v[132:135], v[36:51]
    s_waitcnt lgkmcnt(1)
    s_setprio 1
    v_mfma_f32_32x32x16_bf16 v[52:67], v[152:155], v[132:135], v[52:67]
    s_setprio 0
    s_waitcnt vmcnt(4)
    v_xor_b32 v157, 96, v165
    ds_read_b128 v[132:135], v157 offset:0
    s_waitcnt lgkmcnt(1)
    v_mfma_f32_32x32x16_bf16 v[68:83], v[140:143], v[136:139], v[68:83]
    ds_read_b64_tr_b16 v[140:141], v158 offset:0
    ds_read_b64_tr_b16 v[142:143], v158 offset:512
    s_add_u32 m0, s56, 8192
    s_add_u32 s3, s60, 57344
    buffer_load_dwordx4 v160, s[20:23], s3 offen lds
    s_setprio 1
    v_mfma_f32_32x32x16_bf16 v[84:99], v[144:147], v[136:139], v[84:99]
    s_setprio 0
    ds_read_b64_tr_b16 v[144:145], v158 offset:2048
    ds_read_b64_tr_b16 v[146:147], v158 offset:2560
    s_add_u32 m0, s56, 9216
    s_add_u32 s3, s60, 86016
    buffer_load_dwordx4 v160, s[20:23], s3 offen lds
    v_mfma_f32_32x32x16_bf16 v[100:115], v[148:151], v[136:139], v[100:115]
    ds_read_b64_tr_b16 v[148:149], v159 offset:0
    ds_read_b64_tr_b16 v[150:151], v159 offset:512
    s_add_u32 m0, s56, 10240
    s_add_u32 s3, s60, 57344
    buffer_load_dwordx4 v160, s[24:27], s3 offen lds
    s_setprio 1
    v_mfma_f32_32x32x16_bf16 v[116:131], v[152:155], v[136:139], v[116:131]
    s_setprio 0
    ds_read_b64_tr_b16 v[152:153], v159 offset:2048
    ds_read_b64_tr_b16 v[154:155], v159 offset:2560
    ds_read_b128 v[136:139], v157 offset:4096
    s_add_u32 m0, s56, 11264
    s_add_u32 s3, s60, 86016
    buffer_load_dwordx4 v160, s[24:27], s3 offen lds
    s_waitcnt lgkmcnt(7)
    v_mfma_f32_32x32x16_bf16 v[4:19], v[140:143], v[132:135], v[4:19]
    s_waitcnt lgkmcnt(5)
    s_setprio 1
    v_mfma_f32_32x32x16_bf16 v[20:35], v[144:147], v[132:135], v[20:35]
    s_setprio 0
    s_waitcnt lgkmcnt(3)
    v_mfma_f32_32x32x16_bf16 v[36:51], v[148:151], v[132:135], v[36:51]
    s_waitcnt lgkmcnt(1)
    s_setprio 1
    v_mfma_f32_32x32x16_bf16 v[52:67], v[152:155], v[132:135], v[52:67]
    s_setprio 0
    s_waitcnt vmcnt(4)
    s_add_u32 s61, s4, 1
    s_and_b32 s61, s61, 7
    s_lshl_b32 s61, s61, 13
    v_add_u32 v165, s61, v156
    ds_read_b128 v[132:135], v165 offset:0
    s_waitcnt lgkmcnt(1)
    v_mfma_f32_32x32x16_bf16 v[68:83], v[140:143], v[136:139], v[68:83]
    ds_read_b64_tr_b16 v[140:141], v158 offset:4096
    ds_read_b64_tr_b16 v[142:143], v158 offset:4608
    s_add_u32 m0, s56, 0
    s_add_u32 s3, s60, 114688
    buffer_load_dwordx4 v160, s[20:23], s3 offen lds
    s_setprio 1
    v_mfma_f32_32x32x16_bf16 v[84:99], v[144:147], v[136:139], v[84:99]
    s_setprio 0
    ds_read_b64_tr_b16 v[144:145], v158 offset:6144
    ds_read_b64_tr_b16 v[146:147], v158 offset:6656
    s_add_u32 m0, s56, 1024
    s_add_u32 s3, s60, 143360
    buffer_load_dwordx4 v160, s[20:23], s3 offen lds
    v_mfma_f32_32x32x16_bf16 v[100:115], v[148:151], v[136:139], v[100:115]
    ds_read_b64_tr_b16 v[148:149], v159 offset:4096
    ds_read_b64_tr_b16 v[150:151], v159 offset:4608
    s_add_u32 m0, s56, 2048
    s_add_u32 s3, s60, 114688
    buffer_load_dwordx4 v160, s[24:27], s3 offen lds
    s_setprio 1
    v_mfma_f32_32x32x16_bf16 v[116:131], v[152:155], v[136:139], v[116:131]
    s_setprio 0
    ds_read_b64_tr_b16 v[152:153], v159 offset:6144
    ds_read_b64_tr_b16 v[154:155], v159 offset:6656
    ds_read_b128 v[136:139], v165 offset:4096
    s_add_u32 m0, s56, 3072
    s_add_u32 s3, s60, 143360
    buffer_load_dwordx4 v160, s[24:27], s3 offen lds
    s_waitcnt lgkmcnt(7)
    v_mfma_f32_32x32x16_bf16 v[4:19], v[140:143], v[132:135], v[4:19]
    s_waitcnt lgkmcnt(5)
    s_setprio 1
    v_mfma_f32_32x32x16_bf16 v[20:35], v[144:147], v[132:135], v[20:35]
    s_setprio 0
    s_waitcnt lgkmcnt(3)
    v_mfma_f32_32x32x16_bf16 v[36:51], v[148:151], v[132:135], v[36:51]
    s_waitcnt lgkmcnt(1)
    s_setprio 1
    v_mfma_f32_32x32x16_bf16 v[52:67], v[152:155], v[132:135], v[52:67]
    s_setprio 0
    s_waitcnt vmcnt(4)
    v_xor_b32 v157, 32, v165
    ds_read_b128 v[132:135], v157 offset:0
    s_waitcnt lgkmcnt(1)
    v_mfma_f32_32x32x16_bf16 v[68:83], v[140:143], v[136:139], v[68:83]
    ds_read_b64_tr_b16 v[140:141], v158 offset:8192
    ds_read_b64_tr_b16 v[142:143], v158 offset:8704
    s_add_u32 m0, s56, 4096
    s_add_u32 s3, s60, 172032
    buffer_load_dwordx4 v160, s[20:23], s3 offen lds
    s_setprio 1
    v_mfma_f32_32x32x16_bf16 v[84:99], v[144:147], v[136:139], v[84:99]
    s_setprio 0
    ds_read_b64_tr_b16 v[144:145], v158 offset:10240
    ds_read_b64_tr_b16 v[146:147], v158 offset:10752
    s_add_u32 m0, s56, 5120
    s_add_u32 s3, s60, 200704
    buffer_load_dwordx4 v160, s[20:23], s3 offen lds
    v_mfma_f32_32x32x16_bf16 v[100:115], v[148:151], v[136:139], v[100:115]
    ds_read_b64_tr_b16 v[148:149], v159 offset:8192
    ds_read_b64_tr_b16 v[150:151], v159 offset:8704
    s_add_u32 m0, s56, 6144
    s_add_u32 s3, s60, 172032
    buffer_load_dwordx4 v160, s[24:27], s3 offen lds
    s_setprio 1
    v_mfma_f32_32x32x16_bf16 v[116:131], v[152:155], v[136:139], v[116:131]
    s_setprio 0
    ds_read_b64_tr_b16 v[152:153], v159 offset:10240
    ds_read_b64_tr_b16 v[154:155], v159 offset:10752
    ds_read_b128 v[136:139], v157 offset:4096
    s_add_u32 m0, s56, 7168
    s_add_u32 s3, s60, 200704
    buffer_load_dwordx4 v160, s[24:27], s3 offen lds
    s_waitcnt lgkmcnt(7)
    v_mfma_f32_32x32x16_bf16 v[4:19], v[140:143], v[132:135], v[4:19]
    s_waitcnt lgkmcnt(5)
    s_setprio 1
    v_mfma_f32_32x32x16_bf16 v[20:35], v[144:147], v[132:135], v[20:35]
    s_setprio 0
    s_waitcnt lgkmcnt(3)
    v_mfma_f32_32x32x16_bf16 v[36:51], v[148:151], v[132:135], v[36:51]
    s_waitcnt lgkmcnt(1)
    s_setprio 1
    v_mfma_f32_32x32x16_bf16 v[52:67], v[152:155], v[132:135], v[52:67]
    s_setprio 0
    s_waitcnt vmcnt(4)
    v_xor_b32 v157, 64, v165
    ds_read_b128 v[132:135], v157 offset:0
    s_waitcnt lgkmcnt(1)
    v_mfma_f32_32x32x16_bf16 v[68:83], v[140:143], v[136:139], v[68:83]
    ds_read_b64_tr_b16 v[140:141], v158 offset:0
    ds_read_b64_tr_b16 v[142:143], v158 offset:512
    s_add_u32 s48, s4, 2
    s_and_b32 s48, s48, 7
    s_mul_i32 s59, s48, 229376
    s_add_u32 s59, s59, s55
    s_add_u32 m0, s56, 8192
    s_add_u32 s3, s59, 0
    buffer_load_dwordx4 v160, s[20:23], s3 offen lds
    s_setprio 1
    v_mfma_f32_32x32x16_bf16 v[84:99], v[144:147], v[136:139], v[84:99]
    s_setprio 0
    ds_read_b64_tr_b16 v[144:145], v158 offset:2048
    ds_read_b64_tr_b16 v[146:147], v158 offset:2560
    s_add_u32 m0, s56, 9216
    s_add_u32 s3, s59, 28672
    buffer_load_dwordx4 v160, s[20:23], s3 offen lds
    v_mfma_f32_32x32x16_bf16 v[100:115], v[148:151], v[136:139], v[100:115]
    ds_read_b64_tr_b16 v[148:149], v159 offset:0
    ds_read_b64_tr_b16 v[150:151], v159 offset:512
    s_add_u32 m0, s56, 10240
    s_add_u32 s3, s59, 0
    buffer_load_dwordx4 v160, s[24:27], s3 offen lds
    s_setprio 1
    v_mfma_f32_32x32x16_bf16 v[116:131], v[152:155], v[136:139], v[116:131]
    s_setprio 0
    ds_read_b64_tr_b16 v[152:153], v159 offset:2048
    ds_read_b64_tr_b16 v[154:155], v159 offset:2560
    ds_read_b128 v[136:139], v157 offset:4096
    s_add_u32 m0, s56, 11264
    s_add_u32 s3, s59, 28672
    buffer_load_dwordx4 v160, s[24:27], s3 offen lds
    s_waitcnt lgkmcnt(7)
    v_mfma_f32_32x32x16_bf16 v[4:19], v[140:143], v[132:135], v[4:19]
    s_waitcnt lgkmcnt(5)
    s_setprio 1
    v_mfma_f32_32x32x16_bf16 v[20:35], v[144:147], v[132:135], v[20:35]
    s_setprio 0
    s_waitcnt lgkmcnt(3)
    v_mfma_f32_32x32x16_bf16 v[36:51], v[148:151], v[132:135], v[36:51]
    s_waitcnt lgkmcnt(1)
    s_setprio 1
    v_mfma_f32_32x32x16_bf16 v[52:67], v[152:155], v[132:135], v[52:67]
    s_setprio 0
    s_waitcnt vmcnt(4)
    v_xor_b32 v157, 96, v165
    ds_read_b128 v[132:135], v157 offset:0
    s_waitcnt lgkmcnt(1)
    v_mfma_f32_32x32x16_bf16 v[68:83], v[140:143], v[136:139], v[68:83]
    ds_read_b64_tr_b16 v[140:141], v158 offset:4096
    ds_read_b64_tr_b16 v[142:143], v158 offset:4608
    s_add_u32 m0, s56, 0
    s_add_u32 s3, s59, 57344
    buffer_load_dwordx4 v160, s[20:23], s3 offen lds
    s_setprio 1
    v_mfma_f32_32x32x16_bf16 v[84:99], v[144:147], v[136:139], v[84:99]
    s_setprio 0
    ds_read_b64_tr_b16 v[144:145], v158 offset:6144
    ds_read_b64_tr_b16 v[146:147], v158 offset:6656
    s_add_u32 m0, s56, 1024
    s_add_u32 s3, s59, 86016
    buffer_load_dwordx4 v160, s[20:23], s3 offen lds
    v_mfma_f32_32x32x16_bf16 v[100:115], v[148:151], v[136:139], v[100:115]
    ds_read_b64_tr_b16 v[148:149], v159 offset:4096
    ds_read_b64_tr_b16 v[150:151], v159 offset:4608
    s_add_u32 m0, s56, 2048
    s_add_u32 s3, s59, 57344
    buffer_load_dwordx4 v160, s[24:27], s3 offen lds
    s_setprio 1
    v_mfma_f32_32x32x16_bf16 v[116:131], v[152:155], v[136:139], v[116:131]
    s_setprio 0
    ds_read_b64_tr_b16 v[152:153], v159 offset:6144
    ds_read_b64_tr_b16 v[154:155], v159 offset:6656
    ds_read_b128 v[136:139], v157 offset:4096
    s_add_u32 m0, s56, 3072
    s_add_u32 s3, s59, 86016
    buffer_load_dwordx4 v160, s[24:27], s3 offen lds
    s_waitcnt lgkmcnt(7)
    v_mfma_f32_32x32x16_bf16 v[4:19], v[140:143], v[132:135], v[4:19]
    s_waitcnt lgkmcnt(5)
    s_setprio 1
    v_mfma_f32_32x32x16_bf16 v[20:35], v[144:147], v[132:135], v[20:35]
    s_setprio 0
    s_waitcnt lgkmcnt(3)
    v_mfma_f32_32x32x16_bf16 v[36:51], v[148:151], v[132:135], v[36:51]
    s_waitcnt lgkmcnt(1)
    s_setprio 1
    v_mfma_f32_32x32x16_bf16 v[52:67], v[152:155], v[132:135], v[52:67]
    s_setprio 0
    s_waitcnt vmcnt(4)
    s_add_u32 s61, s4, 2
    s_and_b32 s61, s61, 7
    s_lshl_b32 s61, s61, 13
    v_add_u32 v165, s61, v156
    ds_read_b128 v[132:135], v165 offset:0
    s_waitcnt lgkmcnt(1)
    v_mfma_f32_32x32x16_bf16 v[68:83], v[140:143], v[136:139], v[68:83]
    ds_read_b64_tr_b16 v[140:141], v158 offset:8192
    ds_read_b64_tr_b16 v[142:143], v158 offset:8704
    s_add_u32 m0, s56, 4096
    s_add_u32 s3, s59, 114688
    buffer_load_dwordx4 v160, s[20:23], s3 offen lds
    s_setprio 1
    v_mfma_f32_32x32x16_bf16 v[84:99], v[144:147], v[136:139], v[84:99]
    s_setprio 0
    ds_read_b64_tr_b16 v[144:145], v158 offset:10240
    ds_read_b64_tr_b16 v[146:147], v158 offset:10752
    s_add_u32 m0, s56, 5120
    s_add_u32 s3, s59, 143360
    buffer_load_dwordx4 v160, s[20:23], s3 offen lds
    v_mfma_f32_32x32x16_bf16 v[100:115], v[148:151], v[136:139], v[100:115]
    ds_read_b64_tr_b16 v[148:149], v159 offset:8192
    ds_read_b64_tr_b16 v[150:151], v159 offset:8704
    s_add_u32 m0, s56, 6144
    s_add_u32 s3, s59, 114688
    buffer_load_dwordx4 v160, s[24:27], s3 offen lds
    s_setprio 1
    v_mfma_f32_32x32x16_bf16 v[116:131], v[152:155], v[136:139], v[116:131]
    s_setprio 0
    ds_read_b64_tr_b16 v[152:153], v159 offset:10240
    ds_read_b64_tr_b16 v[154:155], v159 offset:10752
    ds_read_b128 v[136:139], v165 offset:4096
    s_add_u32 m0, s56, 7168
    s_add_u32 s3, s59, 143360
    buffer_load_dwordx4 v160, s[24:27], s3 offen lds
    s_waitcnt lgkmcnt(7)
    v_mfma_f32_32x32x16_bf16 v[4:19], v[140:143], v[132:135], v[4:19]
    s_waitcnt lgkmcnt(5)
    s_setprio 1
    v_mfma_f32_32x32x16_bf16 v[20:35], v[144:147], v[132:135], v[20:35]
    s_setprio 0
    s_waitcnt lgkmcnt(3)
    v_mfma_f32_32x32x16_bf16 v[36:51], v[148:151], v[132:135], v[36:51]
    s_waitcnt lgkmcnt(1)
    s_setprio 1
    v_mfma_f32_32x32x16_bf16 v[52:67], v[152:155], v[132:135], v[52:67]
    s_setprio 0
    s_waitcnt vmcnt(4)
    v_xor_b32 v157, 32, v165
    ds_read_b128 v[132:135], v157 offset:0
    s_waitcnt lgkmcnt(1)
    v_mfma_f32_32x32x16_bf16 v[68:83], v[140:143], v[136:139], v[68:83]
    ds_read_b64_tr_b16 v[140:141], v158 offset:0
    ds_read_b64_tr_b16 v[142:143], v158 offset:512
    s_add_u32 m0, s56, 8192
    s_add_u32 s3, s59, 172032
    buffer_load_dwordx4 v160, s[20:23], s3 offen lds
    s_setprio 1
    v_mfma_f32_32x32x16_bf16 v[84:99], v[144:147], v[136:139], v[84:99]
    s_setprio 0
    ds_read_b64_tr_b16 v[144:145], v158 offset:2048
    ds_read_b64_tr_b16 v[146:147], v158 offset:2560
    s_add_u32 m0, s56, 9216
    s_add_u32 s3, s59, 200704
    buffer_load_dwordx4 v160, s[20:23], s3 offen lds
    v_mfma_f32_32x32x16_bf16 v[100:115], v[148:151], v[136:139], v[100:115]
    ds_read_b64_tr_b16 v[148:149], v159 offset:0
    ds_read_b64_tr_b16 v[150:151], v159 offset:512
    s_add_u32 m0, s56, 10240
    s_add_u32 s3, s59, 172032
    buffer_load_dwordx4 v160, s[24:27], s3 offen lds
    s_setprio 1
    v_mfma_f32_32x32x16_bf16 v[116:131], v[152:155], v[136:139], v[116:131]
    s_setprio 0
    ds_read_b64_tr_b16 v[152:153], v159 offset:2048
    ds_read_b64_tr_b16 v[154:155], v159 offset:2560
    ds_read_b128 v[136:139], v157 offset:4096
    s_add_u32 m0, s56, 11264
    s_add_u32 s3, s59, 200704
    buffer_load_dwordx4 v160, s[24:27], s3 offen lds
    s_waitcnt lgkmcnt(7)
    v_mfma_f32_32x32x16_bf16 v[4:19], v[140:143], v[132:135], v[4:19]
    s_waitcnt lgkmcnt(5)
    s_setprio 1
    v_mfma_f32_32x32x16_bf16 v[20:35], v[144:147], v[132:135], v[20:35]
    s_setprio 0
    s_waitcnt lgkmcnt(3)
    v_mfma_f32_32x32x16_bf16 v[36:51], v[148:151], v[132:135], v[36:51]
    s_waitcnt lgkmcnt(1)
    s_setprio 1
    v_mfma_f32_32x32x16_bf16 v[52:67], v[152:155], v[132:135], v[52:67]
    s_setprio 0
    s_waitcnt vmcnt(4)
    v_xor_b32 v157, 64, v165
    ds_read_b128 v[132:135], v157 offset:0
    s_waitcnt lgkmcnt(1)
    v_mfma_f32_32x32x16_bf16 v[68:83], v[140:143], v[136:139], v[68:83]
    ds_read_b64_tr_b16 v[140:141], v158 offset:4096
    ds_read_b64_tr_b16 v[142:143], v158 offset:4608
    s_add_u32 s48, s4, 3
    s_and_b32 s48, s48, 7
    s_mul_i32 s60, s48, 229376
    s_add_u32 s60, s60, s55
    s_add_u32 m0, s56, 0
    s_add_u32 s3, s60, 0
    buffer_load_dwordx4 v160, s[20:23], s3 offen lds
    s_setprio 1
    v_mfma_f32_32x32x16_bf16 v[84:99], v[144:147], v[136:139], v[84:99]
    s_setprio 0
    ds_read_b64_tr_b16 v[144:145], v158 offset:6144
    ds_read_b64_tr_b16 v[146:147], v158 offset:6656
    s_add_u32 m0, s56, 1024
    s_add_u32 s3, s60, 28672
    buffer_load_dwordx4 v160, s[20:23], s3 offen lds
    v_mfma_f32_32x32x16_bf16 v[100:115], v[148:151], v[136:139], v[100:115]
    ds_read_b64_tr_b16 v[148:149], v159 offset:4096
    ds_read_b64_tr_b16 v[150:151], v159 offset:4608
    s_add_u32 m0, s56, 2048
    s_add_u32 s3, s60, 0
    buffer_load_dwordx4 v160, s[24:27], s3 offen lds
    s_setprio 1
    v_mfma_f32_32x32x16_bf16 v[116:131], v[152:155], v[136:139], v[116:131]
    s_setprio 0
    ds_read_b64_tr_b16 v[152:153], v159 offset:6144
    ds_read_b64_tr_b16 v[154:155], v159 offset:6656
    ds_read_b128 v[136:139], v157 offset:4096
    s_add_u32 m0, s56, 3072
    s_add_u32 s3, s60, 28672
    buffer_load_dwordx4 v160, s[24:27], s3 offen lds
    s_waitcnt lgkmcnt(7)
    v_mfma_f32_32x32x16_bf16 v[4:19], v[140:143], v[132:135], v[4:19]
    s_waitcnt lgkmcnt(5)
    s_setprio 1
    v_mfma_f32_32x32x16_bf16 v[20:35], v[144:147], v[132:135], v[20:35]
    s_setprio 0
    s_waitcnt lgkmcnt(3)
    v_mfma_f32_32x32x16_bf16 v[36:51], v[148:151], v[132:135], v[36:51]
    s_waitcnt lgkmcnt(1)
    s_setprio 1
    v_mfma_f32_32x32x16_bf16 v[52:67], v[152:155], v[132:135], v[52:67]
    s_setprio 0
    s_waitcnt vmcnt(4)
    v_xor_b32 v157, 96, v165
    ds_read_b128 v[132:135], v157 offset:0
    s_waitcnt lgkmcnt(1)
    v_mfma_f32_32x32x16_bf16 v[68:83], v[140:143], v[136:139], v[68:83]
    ds_read_b64_tr_b16 v[140:141], v158 offset:8192
    ds_read_b64_tr_b16 v[142:143], v158 offset:8704
    s_add_u32 m0, s56, 4096
    s_add_u32 s3, s60, 57344
    buffer_load_dwordx4 v160, s[20:23], s3 offen lds
    s_setprio 1
    v_mfma_f32_32x32x16_bf16 v[84:99], v[144:147], v[136:139], v[84:99]
    s_setprio 0
    ds_read_b64_tr_b16 v[144:145], v158 offset:10240
    ds_read_b64_tr_b16 v[146:147], v158 offset:10752
    s_add_u32 m0, s56, 5120
    s_add_u32 s3, s60, 86016
    buffer_load_dwordx4 v160, s[20:23], s3 offen lds
    v_mfma_f32_32x32x16_bf16 v[100:115], v[148:151], v[136:139], v[100:115]
    ds_read_b64_tr_b16 v[148:149], v159 offset:8192
    ds_read_b64_tr_b16 v[150:151], v159 offset:8704
    s_add_u32 m0, s56, 6144
    s_add_u32 s3, s60, 57344
    buffer_load_dwordx4 v160, s[24:27], s3 offen lds
    s_setprio 1
    v_mfma_f32_32x32x16_bf16 v[116:131], v[152:155], v[136:139], v[116:131]
    s_setprio 0
    ds_read_b64_tr_b16 v[152:153], v159 offset:10240
    ds_read_b64_tr_b16 v[154:155], v159 offset:10752
    ds_read_b128 v[136:139], v157 offset:4096
    s_add_u32 m0, s56, 7168
    s_add_u32 s3, s60, 86016
    buffer_load_dwordx4 v160, s[24:27], s3 offen lds
    s_waitcnt lgkmcnt(7)
    v_mfma_f32_32x32x16_bf16 v[4:19], v[140:143], v[132:135], v[4:19]
    s_waitcnt lgkmcnt(5)
    s_setprio 1
    v_mfma_f32_32x32x16_bf16 v[20:35], v[144:147], v[132:135], v[20:35]
    s_setprio 0
    s_waitcnt lgkmcnt(3)
    v_mfma_f32_32x32x16_bf16 v[36:51], v[148:151], v[132:135], v[36:51]
    s_waitcnt lgkmcnt(1)
    s_setprio 1
    v_mfma_f32_32x32x16_bf16 v[52:67], v[152:155], v[132:135], v[52:67]
    s_setprio 0
    s_waitcnt vmcnt(4)
    s_add_u32 s61, s4, 3
    s_and_b32 s61, s61, 7
    s_lshl_b32 s61, s61, 13
    v_add_u32 v165, s61, v156
    ds_read_b128 v[132:135], v165 offset:0
    s_waitcnt lgkmcnt(1)
    v_mfma_f32_32x32x16_bf16 v[68:83], v[140:143], v[136:139], v[68:83]
    ds_read_b64_tr_b16 v[140:141], v158 offset:0
    ds_read_b64_tr_b16 v[142:143], v158 offset:512
    s_add_u32 m0, s56, 8192
    s_add_u32 s3, s60, 114688
    buffer_load_dwordx4 v160, s[20:23], s3 offen lds
    s_setprio 1
    v_mfma_f32_32x32x16_bf16 v[84:99], v[144:147], v[136:139], v[84:99]
    s_setprio 0
    ds_read_b64_tr_b16 v[144:145], v158 offset:2048
    ds_read_b64_tr_b16 v[146:147], v158 offset:2560
    s_add_u32 m0, s56, 9216
    s_add_u32 s3, s60, 143360
    buffer_load_dwordx4 v160, s[20:23], s3 offen lds
    v_mfma_f32_32x32x16_bf16 v[100:115], v[148:151], v[136:139], v[100:115]
    ds_read_b64_tr_b16 v[148:149], v159 offset:0
    ds_read_b64_tr_b16 v[150:151], v159 offset:512
    s_add_u32 m0, s56, 10240
    s_add_u32 s3, s60, 114688
    buffer_load_dwordx4 v160, s[24:27], s3 offen lds
    s_setprio 1
    v_mfma_f32_32x32x16_bf16 v[116:131], v[152:155], v[136:139], v[116:131]
    s_setprio 0
    ds_read_b64_tr_b16 v[152:153], v159 offset:2048
    ds_read_b64_tr_b16 v[154:155], v159 offset:2560
    ds_read_b128 v[136:139], v165 offset:4096
    s_add_u32 m0, s56, 11264
    s_add_u32 s3, s60, 143360
    buffer_load_dwordx4 v160, s[24:27], s3 offen lds
    s_waitcnt lgkmcnt(7)
    v_mfma_f32_32x32x16_bf16 v[4:19], v[140:143], v[132:135], v[4:19]
    s_waitcnt lgkmcnt(5)
    s_setprio 1
    v_mfma_f32_32x32x16_bf16 v[20:35], v[144:147], v[132:135], v[20:35]
    s_setprio 0
    s_waitcnt lgkmcnt(3)
    v_mfma_f32_32x32x16_bf16 v[36:51], v[148:151], v[132:135], v[36:51]
    s_waitcnt lgkmcnt(1)
    s_setprio 1
    v_mfma_f32_32x32x16_bf16 v[52:67], v[152:155], v[132:135], v[52:67]
    s_setprio 0
    s_waitcnt vmcnt(4)
    v_xor_b32 v157, 32, v165
    ds_read_b128 v[132:135], v157 offset:0
    s_waitcnt lgkmcnt(1)
    v_mfma_f32_32x32x16_bf16 v[68:83], v[140:143], v[136:139], v[68:83]
    ds_read_b64_tr_b16 v[140:141], v158 offset:4096
    ds_read_b64_tr_b16 v[142:143], v158 offset:4608
    s_add_u32 m0, s56, 0
    s_add_u32 s3, s60, 172032
    buffer_load_dwordx4 v160, s[20:23], s3 offen lds
    s_setprio 1
    v_mfma_f32_32x32x16_bf16 v[84:99], v[144:147], v[136:139], v[84:99]
    s_setprio 0
    ds_read_b64_tr_b16 v[144:145], v158 offset:6144
    ds_read_b64_tr_b16 v[146:147], v158 offset:6656
    s_add_u32 m0, s56, 1024
    s_add_u32 s3, s60, 200704
    buffer_load_dwordx4 v160, s[20:23], s3 offen lds
    v_mfma_f32_32x32x16_bf16 v[100:115], v[148:151], v[136:139], v[100:115]
    ds_read_b64_tr_b16 v[148:149], v159 offset:4096
    ds_read_b64_tr_b16 v[150:151], v159 offset:4608
    s_add_u32 m0, s56, 2048
    s_add_u32 s3, s60, 172032
    buffer_load_dwordx4 v160, s[24:27], s3 offen lds
    s_setprio 1
    v_mfma_f32_32x32x16_bf16 v[116:131], v[152:155], v[136:139], v[116:131]
    s_setprio 0
    ds_read_b64_tr_b16 v[152:153], v159 offset:6144
    ds_read_b64_tr_b16 v[154:155], v159 offset:6656
    ds_read_b128 v[136:139], v157 offset:4096
    s_add_u32 m0, s56, 3072
    s_add_u32 s3, s60, 200704
    buffer_load_dwordx4 v160, s[24:27], s3 offen lds
    s_waitcnt lgkmcnt(7)
    v_mfma_f32_32x32x16_bf16 v[4:19], v[140:143], v[132:135], v[4:19]
    s_waitcnt lgkmcnt(5)
    s_setprio 1
    v_mfma_f32_32x32x16_bf16 v[20:35], v[144:147], v[132:135], v[20:35]
    s_setprio 0
    s_waitcnt lgkmcnt(3)
    v_mfma_f32_32x32x16_bf16 v[36:51], v[148:151], v[132:135], v[36:51]
    s_waitcnt lgkmcnt(1)
    s_setprio 1
    v_mfma_f32_32x32x16_bf16 v[52:67], v[152:155], v[132:135], v[52:67]
    s_setprio 0
    s_waitcnt vmcnt(4)
    v_xor_b32 v157, 64, v165
    ds_read_b128 v[132:135], v157 offset:0
    s_waitcnt lgkmcnt(1)
    v_mfma_f32_32x32x16_bf16 v[68:83], v[140:143], v[136:139], v[68:83]
    ds_read_b64_tr_b16 v[140:141], v158 offset:8192
    ds_read_b64_tr_b16 v[142:143], v158 offset:8704
    s_add_u32 s48, s4, 4
    s_and_b32 s48, s48, 7
    s_mul_i32 s59, s48, 229376
    s_add_u32 s59, s59, s55
    s_add_u32 m0, s56, 4096
    s_add_u32 s3, s59, 0
    buffer_load_dwordx4 v160, s[20:23], s3 offen lds
    s_setprio 1
    v_mfma_f32_32x32x16_bf16 v[84:99], v[144:147], v[136:139], v[84:99]
    s_setprio 0
    ds_read_b64_tr_b16 v[144:145], v158 offset:10240
    ds_read_b64_tr_b16 v[146:147], v158 offset:10752
    s_add_u32 m0, s56, 5120
    s_add_u32 s3, s59, 28672
    buffer_load_dwordx4 v160, s[20:23], s3 offen lds
    v_mfma_f32_32x32x16_bf16 v[100:115], v[148:151], v[136:139], v[100:115]
    ds_read_b64_tr_b16 v[148:149], v159 offset:8192
    ds_read_b64_tr_b16 v[150:151], v159 offset:8704
    s_add_u32 m0, s56, 6144
    s_add_u32 s3, s59, 0
    buffer_load_dwordx4 v160, s[24:27], s3 offen lds
    s_setprio 1
    v_mfma_f32_32x32x16_bf16 v[116:131], v[152:155], v[136:139], v[116:131]
    s_setprio 0
    ds_read_b64_tr_b16 v[152:153], v159 offset:10240
    ds_read_b64_tr_b16 v[154:155], v159 offset:10752
    ds_read_b128 v[136:139], v157 offset:4096
    s_add_u32 m0, s56, 7168
    s_add_u32 s3, s59, 28672
    buffer_load_dwordx4 v160, s[24:27], s3 offen lds
    s_waitcnt lgkmcnt(7)
    v_mfma_f32_32x32x16_bf16 v[4:19], v[140:143], v[132:135], v[4:19]
    s_waitcnt lgkmcnt(5)
    s_setprio 1
    v_mfma_f32_32x32x16_bf16 v[20:35], v[144:147], v[132:135], v[20:35]
    s_setprio 0
    s_waitcnt lgkmcnt(3)
    v_mfma_f32_32x32x16_bf16 v[36:51], v[148:151], v[132:135], v[36:51]
    s_waitcnt lgkmcnt(1)
    s_setprio 1
    v_mfma_f32_32x32x16_bf16 v[52:67], v[152:155], v[132:135], v[52:67]
    s_setprio 0
    s_waitcnt vmcnt(4)
    v_xor_b32 v157, 96, v165
    ds_read_b128 v[132:135], v157 offset:0
    s_waitcnt lgkmcnt(1)
    v_mfma_f32_32x32x16_bf16 v[68:83], v[140:143], v[136:139], v[68:83]
    ds_read_b64_tr_b16 v[140:141], v158 offset:0
    ds_read_b64_tr_b16 v[142:143], v158 offset:512
    s_add_u32 m0, s56, 8192
    s_add_u32 s3, s59, 57344
    buffer_load_dwordx4 v160, s[20:23], s3 offen lds
    s_setprio 1
    v_mfma_f32_32x32x16_bf16 v[84:99], v[144:147], v[136:139], v[84:99]
    s_setprio 0
    ds_read_b64_tr_b16 v[144:145], v158 offset:2048
    ds_read_b64_tr_b16 v[146:147], v158 offset:2560
    s_add_u32 m0, s56, 9216
    s_add_u32 s3, s59, 86016
    buffer_load_dwordx4 v160, s[20:23], s3 offen lds
    v_mfma_f32_32x32x16_bf16 v[100:115], v[148:151], v[136:139], v[100:115]
    ds_read_b64_tr_b16 v[148:149], v159 offset:0
    ds_read_b64_tr_b16 v[150:151], v159 offset:512
    s_add_u32 m0, s56, 10240
    s_add_u32 s3, s59, 57344
    buffer_load_dwordx4 v160, s[24:27], s3 offen lds
    s_setprio 1
    v_mfma_f32_32x32x16_bf16 v[116:131], v[152:155], v[136:139], v[116:131]
    s_setprio 0
    ds_read_b64_tr_b16 v[152:153], v159 offset:2048
    ds_read_b64_tr_b16 v[154:155], v159 offset:2560
    ds_read_b128 v[136:139], v157 offset:4096
    s_add_u32 m0, s56, 11264
    s_add_u32 s3, s59, 86016
    buffer_load_dwordx4 v160, s[24:27], s3 offen lds
    s_waitcnt lgkmcnt(7)
    v_mfma_f32_32x32x16_bf16 v[4:19], v[140:143], v[132:135], v[4:19]
    s_waitcnt lgkmcnt(5)
    s_setprio 1
    v_mfma_f32_32x32x16_bf16 v[20:35], v[144:147], v[132:135], v[20:35]
    s_setprio 0
    s_waitcnt lgkmcnt(3)
    v_mfma_f32_32x32x16_bf16 v[36:51], v[148:151], v[132:135], v[36:51]
    s_waitcnt lgkmcnt(1)
    s_setprio 1
    v_mfma_f32_32x32x16_bf16 v[52:67], v[152:155], v[132:135], v[52:67]
    s_setprio 0
    s_waitcnt vmcnt(4)
    s_add_u32 s61, s4, 4
    s_and_b32 s61, s61, 7
    s_lshl_b32 s61, s61, 13
    v_add_u32 v165, s61, v156
    ds_read_b128 v[132:135], v165 offset:0
    s_waitcnt lgkmcnt(1)
    v_mfma_f32_32x32x16_bf16 v[68:83], v[140:143], v[136:139], v[68:83]
    ds_read_b64_tr_b16 v[140:141], v158 offset:4096
    ds_read_b64_tr_b16 v[142:143], v158 offset:4608
    s_add_u32 m0, s56, 0
    s_add_u32 s3, s59, 114688
    buffer_load_dwordx4 v160, s[20:23], s3 offen lds
    s_setprio 1
    v_mfma_f32_32x32x16_bf16 v[84:99], v[144:147], v[136:139], v[84:99]
    s_setprio 0
    ds_read_b64_tr_b16 v[144:145], v158 offset:6144
    ds_read_b64_tr_b16 v[146:147], v158 offset:6656
    s_add_u32 m0, s56, 1024
    s_add_u32 s3, s59, 143360
    buffer_load_dwordx4 v160, s[20:23], s3 offen lds
    v_mfma_f32_32x32x16_bf16 v[100:115], v[148:151], v[136:139], v[100:115]
    ds_read_b64_tr_b16 v[148:149], v159 offset:4096
    ds_read_b64_tr_b16 v[150:151], v159 offset:4608
    s_add_u32 m0, s56, 2048
    s_add_u32 s3, s59, 114688
    buffer_load_dwordx4 v160, s[24:27], s3 offen lds
    s_setprio 1
    v_mfma_f32_32x32x16_bf16 v[116:131], v[152:155], v[136:139], v[116:131]
    s_setprio 0
    ds_read_b64_tr_b16 v[152:153], v159 offset:6144
    ds_read_b64_tr_b16 v[154:155], v159 offset:6656
    ds_read_b128 v[136:139], v165 offset:4096
    s_add_u32 m0, s56, 3072
    s_add_u32 s3, s59, 143360
    buffer_load_dwordx4 v160, s[24:27], s3 offen lds
    s_waitcnt lgkmcnt(7)
    v_mfma_f32_32x32x16_bf16 v[4:19], v[140:143], v[132:135], v[4:19]
    s_waitcnt lgkmcnt(5)
    s_setprio 1
    v_mfma_f32_32x32x16_bf16 v[20:35], v[144:147], v[132:135], v[20:35]
    s_setprio 0
    s_waitcnt lgkmcnt(3)
    v_mfma_f32_32x32x16_bf16 v[36:51], v[148:151], v[132:135], v[36:51]
    s_waitcnt lgkmcnt(1)
    s_setprio 1
    v_mfma_f32_32x32x16_bf16 v[52:67], v[152:155], v[132:135], v[52:67]
    s_setprio 0
    s_waitcnt vmcnt(4)
    v_xor_b32 v157, 32, v165
    ds_read_b128 v[132:135], v157 offset:0
    s_waitcnt lgkmcnt(1)
    v_mfma_f32_32x32x16_bf16 v[68:83], v[140:143], v[136:139], v[68:83]
    ds_read_b64_tr_b16 v[140:141], v158 offset:8192
    ds_read_b64_tr_b16 v[142:143], v158 offset:8704
    s_add_u32 m0, s56, 4096
    s_add_u32 s3, s59, 172032
    buffer_load_dwordx4 v160, s[20:23], s3 offen lds
    s_setprio 1
    v_mfma_f32_32x32x16_bf16 v[84:99], v[144:147], v[136:139], v[84:99]
    s_setprio 0
    ds_read_b64_tr_b16 v[144:145], v158 offset:10240
    ds_read_b64_tr_b16 v[146:147], v158 offset:10752
    s_add_u32 m0, s56, 5120
    s_add_u32 s3, s59, 200704
    buffer_load_dwordx4 v160, s[20:23], s3 offen lds
    v_mfma_f32_32x32x16_bf16 v[100:115], v[148:151], v[136:139], v[100:115]
    ds_read_b64_tr_b16 v[148:149], v159 offset:8192
    ds_read_b64_tr_b16 v[150:151], v159 offset:8704
    s_add_u32 m0, s56, 6144
    s_add_u32 s3, s59, 172032
    buffer_load_dwordx4 v160, s[24:27], s3 offen lds
    s_setprio 1
    v_mfma_f32_32x32x16_bf16 v[116:131], v[152:155], v[136:139], v[116:131]
    s_setprio 0
    ds_read_b64_tr_b16 v[152:153], v159 offset:10240
    ds_read_b64_tr_b16 v[154:155], v159 offset:10752
    ds_read_b128 v[136:139], v157 offset:4096
    s_add_u32 m0, s56, 7168
    s_add_u32 s3, s59, 200704
    buffer_load_dwordx4 v160, s[24:27], s3 offen lds
    s_waitcnt lgkmcnt(7)
    v_mfma_f32_32x32x16_bf16 v[4:19], v[140:143], v[132:135], v[4:19]
    s_waitcnt lgkmcnt(5)
    s_setprio 1
    v_mfma_f32_32x32x16_bf16 v[20:35], v[144:147], v[132:135], v[20:35]
    s_setprio 0
    s_waitcnt lgkmcnt(3)
    v_mfma_f32_32x32x16_bf16 v[36:51], v[148:151], v[132:135], v[36:51]
    s_waitcnt lgkmcnt(1)
    s_setprio 1
    v_mfma_f32_32x32x16_bf16 v[52:67], v[152:155], v[132:135], v[52:67]
    s_setprio 0
    s_waitcnt vmcnt(4)
    v_xor_b32 v157, 64, v165
    ds_read_b128 v[132:135], v157 offset:0
    s_waitcnt lgkmcnt(1)
    v_mfma_f32_32x32x16_bf16 v[68:83], v[140:143], v[136:139], v[68:83]
    ds_read_b64_tr_b16 v[140:141], v158 offset:0
    ds_read_b64_tr_b16 v[142:143], v158 offset:512
    s_add_u32 s48, s4, 5
    s_and_b32 s48, s48, 7
    s_mul_i32 s60, s48, 229376
    s_add_u32 s60, s60, s55
    s_add_u32 m0, s56, 8192
    s_add_u32 s3, s60, 0
    buffer_load_dwordx4 v160, s[20:23], s3 offen lds
    s_setprio 1
    v_mfma_f32_32x32x16_bf16 v[84:99], v[144:147], v[136:139], v[84:99]
    s_setprio 0
    ds_read_b64_tr_b16 v[144:145], v158 offset:2048
    ds_read_b64_tr_b16 v[146:147], v158 offset:2560
    s_add_u32 m0, s56, 9216
    s_add_u32 s3, s60, 28672
    buffer_load_dwordx4 v160, s[20:23], s3 offen lds
    v_mfma_f32_32x32x16_bf16 v[100:115], v[148:151], v[136:139], v[100:115]
    ds_read_b64_tr_b16 v[148:149], v159 offset:0
    ds_read_b64_tr_b16 v[150:151], v159 offset:512
    s_add_u32 m0, s56, 10240
    s_add_u32 s3, s60, 0
    buffer_load_dwordx4 v160, s[24:27], s3 offen lds
    s_setprio 1
    v_mfma_f32_32x32x16_bf16 v[116:131], v[152:155], v[136:139], v[116:131]
    s_setprio 0
    ds_read_b64_tr_b16 v[152:153], v159 offset:2048
    ds_read_b64_tr_b16 v[154:155], v159 offset:2560
    ds_read_b128 v[136:139], v157 offset:4096
    s_add_u32 m0, s56, 11264
    s_add_u32 s3, s60, 28672
    buffer_load_dwordx4 v160, s[24:27], s3 offen lds
    s_waitcnt lgkmcnt(7)
    v_mfma_f32_32x32x16_bf16 v[4:19], v[140:143], v[132:135], v[4:19]
    s_waitcnt lgkmcnt(5)
    s_setprio 1
    v_mfma_f32_32x32x16_bf16 v[20:35], v[144:147], v[132:135], v[20:35]
    s_setprio 0
    s_waitcnt lgkmcnt(3)
    v_mfma_f32_32x32x16_bf16 v[36:51], v[148:151], v[132:135], v[36:51]
    s_waitcnt lgkmcnt(1)
    s_setprio 1
    v_mfma_f32_32x32x16_bf16 v[52:67], v[152:155], v[132:135], v[52:67]
    s_setprio 0
    s_waitcnt vmcnt(4)
    v_xor_b32 v157, 96, v165
    ds_read_b128 v[132:135], v157 offset:0
    s_waitcnt lgkmcnt(1)
    v_mfma_f32_32x32x16_bf16 v[68:83], v[140:143], v[136:139], v[68:83]
    ds_read_b64_tr_b16 v[140:141], v158 offset:4096
    ds_read_b64_tr_b16 v[142:143], v158 offset:4608
    s_add_u32 m0, s56, 0
    s_add_u32 s3, s60, 57344
    buffer_load_dwordx4 v160, s[20:23], s3 offen lds
    s_setprio 1
    v_mfma_f32_32x32x16_bf16 v[84:99], v[144:147], v[136:139], v[84:99]
    s_setprio 0
    ds_read_b64_tr_b16 v[144:145], v158 offset:6144
    ds_read_b64_tr_b16 v[146:147], v158 offset:6656
    s_add_u32 m0, s56, 1024
    s_add_u32 s3, s60, 86016
    buffer_load_dwordx4 v160, s[20:23], s3 offen lds
    v_mfma_f32_32x32x16_bf16 v[100:115], v[148:151], v[136:139], v[100:115]
    ds_read_b64_tr_b16 v[148:149], v159 offset:4096
    ds_read_b64_tr_b16 v[150:151], v159 offset:4608
    s_add_u32 m0, s56, 2048
    s_add_u32 s3, s60, 57344
    buffer_load_dwordx4 v160, s[24:27], s3 offen lds
    s_setprio 1
    v_mfma_f32_32x32x16_bf16 v[116:131], v[152:155], v[136:139], v[116:131]
    s_setprio 0
    ds_read_b64_tr_b16 v[152:153], v159 offset:6144
    ds_read_b64_tr_b16 v[154:155], v159 offset:6656
    ds_read_b128 v[136:139], v157 offset:4096
    s_add_u32 m0, s56, 3072
    s_add_u32 s3, s60, 86016
    buffer_load_dwordx4 v160, s[24:27], s3 offen lds
    s_waitcnt lgkmcnt(7)
    v_mfma_f32_32x32x16_bf16 v[4:19], v[140:143], v[132:135], v[4:19]
    s_waitcnt lgkmcnt(5)
    s_setprio 1
    v_mfma_f32_32x32x16_bf16 v[20:35], v[144:147], v[132:135], v[20:35]
    s_setprio 0
    s_waitcnt lgkmcnt(3)
    v_mfma_f32_32x32x16_bf16 v[36:51], v[148:151], v[132:135], v[36:51]
    s_waitcnt lgkmcnt(1)
    s_setprio 1
    v_mfma_f32_32x32x16_bf16 v[52:67], v[152:155], v[132:135], v[52:67]
    s_setprio 0
    s_waitcnt vmcnt(4)
    s_add_u32 s61, s4, 5
    s_and_b32 s61, s61, 7
    s_lshl_b32 s61, s61, 13
    v_add_u32 v165, s61, v156
    ds_read_b128 v[132:135], v165 offset:0
    s_waitcnt lgkmcnt(1)
    v_mfma_f32_32x32x16_bf16 v[68:83], v[140:143], v[136:139], v[68:83]
    ds_read_b64_tr_b16 v[140:141], v158 offset:8192
    ds_read_b64_tr_b16 v[142:143], v158 offset:8704
    s_add_u32 m0, s56, 4096
    s_add_u32 s3, s60, 114688
    buffer_load_dwordx4 v160, s[20:23], s3 offen lds
    s_setprio 1
    v_mfma_f32_32x32x16_bf16 v[84:99], v[144:147], v[136:139], v[84:99]
    s_setprio 0
    ds_read_b64_tr_b16 v[144:145], v158 offset:10240
    ds_read_b64_tr_b16 v[146:147], v158 offset:10752
    s_add_u32 m0, s56, 5120
    s_add_u32 s3, s60, 143360
    buffer_load_dwordx4 v160, s[20:23], s3 offen lds
    v_mfma_f32_32x32x16_bf16 v[100:115], v[148:151], v[136:139], v[100:115]
    ds_read_b64_tr_b16 v[148:149], v159 offset:8192
    ds_read_b64_tr_b16 v[150:151], v159 offset:8704
    s_add_u32 m0, s56, 6144
    s_add_u32 s3, s60, 114688
    buffer_load_dwordx4 v160, s[24:27], s3 offen lds
    s_setprio 1
    v_mfma_f32_32x32x16_bf16 v[116:131], v[152:155], v[136:139], v[116:131]
    s_setprio 0
    ds_read_b64_tr_b16 v[152:153], v159 offset:10240
    ds_read_b64_tr_b16 v[154:155], v159 offset:10752
    ds_read_b128 v[136:139], v165 offset:4096
    s_add_u32 m0, s56, 7168
    s_add_u32 s3, s60, 143360
    buffer_load_dwordx4 v160, s[24:27], s3 offen lds
    s_waitcnt lgkmcnt(7)
    v_mfma_f32_32x32x16_bf16 v[4:19], v[140:143], v[132:135], v[4:19]
    s_waitcnt lgkmcnt(5)
    s_setprio 1
    v_mfma_f32_32x32x16_bf16 v[20:35], v[144:147], v[132:135], v[20:35]
    s_setprio 0
    s_waitcnt lgkmcnt(3)
    v_mfma_f32_32x32x16_bf16 v[36:51], v[148:151], v[132:135], v[36:51]
    s_waitcnt lgkmcnt(1)
    s_setprio 1
    v_mfma_f32_32x32x16_bf16 v[52:67], v[152:155], v[132:135], v[52:67]
    s_setprio 0
    s_waitcnt vmcnt(4)
    v_xor_b32 v157, 32, v165
    ds_read_b128 v[132:135], v157 offset:0
    s_waitcnt lgkmcnt(1)
    v_mfma_f32_32x32x16_bf16 v[68:83], v[140:143], v[136:139], v[68:83]
    ds_read_b64_tr_b16 v[140:141], v158 offset:0
    ds_read_b64_tr_b16 v[142:143], v158 offset:512
    s_add_u32 m0, s56, 8192
    s_add_u32 s3, s60, 172032
    buffer_load_dwordx4 v160, s[20:23], s3 offen lds
    s_setprio 1
    v_mfma_f32_32x32x16_bf16 v[84:99], v[144:147], v[136:139], v[84:99]
    s_setprio 0
    ds_read_b64_tr_b16 v[144:145], v158 offset:2048
    ds_read_b64_tr_b16 v[146:147], v158 offset:2560
    s_add_u32 m0, s56, 9216
    s_add_u32 s3, s60, 200704
    buffer_load_dwordx4 v160, s[20:23], s3 offen lds
    v_mfma_f32_32x32x16_bf16 v[100:115], v[148:151], v[136:139], v[100:115]
    ds_read_b64_tr_b16 v[148:149], v159 offset:0
    ds_read_b64_tr_b16 v[150:151], v159 offset:512
    s_add_u32 m0, s56, 10240
    s_add_u32 s3, s60, 172032
    buffer_load_dwordx4 v160, s[24:27], s3 offen lds
    s_setprio 1
    v_mfma_f32_32x32x16_bf16 v[116:131], v[152:155], v[136:139], v[116:131]
    s_setprio 0
    ds_read_b64_tr_b16 v[152:153], v159 offset:2048
    ds_read_b64_tr_b16 v[154:155], v159 offset:2560
    ds_read_b128 v[136:139], v157 offset:4096
    s_add_u32 m0, s56, 11264
    s_add_u32 s3, s60, 200704
    buffer_load_dwordx4 v160, s[24:27], s3 offen lds
    s_waitcnt lgkmcnt(7)
    v_mfma_f32_32x32x16_bf16 v[4:19], v[140:143], v[132:135], v[4:19]
    s_waitcnt lgkmcnt(5)
    s_setprio 1
    v_mfma_f32_32x32x16_bf16 v[20:35], v[144:147], v[132:135], v[20:35]
    s_setprio 0
    s_waitcnt lgkmcnt(3)
    v_mfma_f32_32x32x16_bf16 v[36:51], v[148:151], v[132:135], v[36:51]
    s_waitcnt lgkmcnt(1)
    s_setprio 1
    v_mfma_f32_32x32x16_bf16 v[52:67], v[152:155], v[132:135], v[52:67]
    s_setprio 0
    s_waitcnt vmcnt(4)
    v_xor_b32 v157, 64, v165
    ds_read_b128 v[132:135], v157 offset:0
    s_waitcnt lgkmcnt(1)
    v_mfma_f32_32x32x16_bf16 v[68:83], v[140:143], v[136:139], v[68:83]
    ds_read_b64_tr_b16 v[140:141], v158 offset:4096
    ds_read_b64_tr_b16 v[142:143], v158 offset:4608
    s_add_u32 s48, s4, 6
    s_and_b32 s48, s48, 7
    s_mul_i32 s59, s48, 229376
    s_add_u32 s59, s59, s55
    s_add_u32 m0, s56, 0
    s_add_u32 s3, s59, 0
    buffer_load_dwordx4 v160, s[20:23], s3 offen lds
    s_setprio 1
    v_mfma_f32_32x32x16_bf16 v[84:99], v[144:147], v[136:139], v[84:99]
    s_setprio 0
    ds_read_b64_tr_b16 v[144:145], v158 offset:6144
    ds_read_b64_tr_b16 v[146:147], v158 offset:6656
    s_add_u32 m0, s56, 1024
    s_add_u32 s3, s59, 28672
    buffer_load_dwordx4 v160, s[20:23], s3 offen lds
    v_mfma_f32_32x32x16_bf16 v[100:115], v[148:151], v[136:139], v[100:115]
    ds_read_b64_tr_b16 v[148:149], v159 offset:4096
    ds_read_b64_tr_b16 v[150:151], v159 offset:4608
    s_add_u32 m0, s56, 2048
    s_add_u32 s3, s59, 0
    buffer_load_dwordx4 v160, s[24:27], s3 offen lds
    s_setprio 1
    v_mfma_f32_32x32x16_bf16 v[116:131], v[152:155], v[136:139], v[116:131]
    s_setprio 0
    ds_read_b64_tr_b16 v[152:153], v159 offset:6144
    ds_read_b64_tr_b16 v[154:155], v159 offset:6656
    ds_read_b128 v[136:139], v157 offset:4096
    s_add_u32 m0, s56, 3072
    s_add_u32 s3, s59, 28672
    buffer_load_dwordx4 v160, s[24:27], s3 offen lds
    s_waitcnt lgkmcnt(7)
    v_mfma_f32_32x32x16_bf16 v[4:19], v[140:143], v[132:135], v[4:19]
    s_waitcnt lgkmcnt(5)
    s_setprio 1
    v_mfma_f32_32x32x16_bf16 v[20:35], v[144:147], v[132:135], v[20:35]
    s_setprio 0
    s_waitcnt lgkmcnt(3)
    v_mfma_f32_32x32x16_bf16 v[36:51], v[148:151], v[132:135], v[36:51]
    s_waitcnt lgkmcnt(1)
    s_setprio 1
    v_mfma_f32_32x32x16_bf16 v[52:67], v[152:155], v[132:135], v[52:67]
    s_setprio 0
    s_waitcnt vmcnt(4)
    v_xor_b32 v157, 96, v165
    ds_read_b128 v[132:135], v157 offset:0
    s_waitcnt lgkmcnt(1)
    v_mfma_f32_32x32x16_bf16 v[68:83], v[140:143], v[136:139], v[68:83]
    ds_read_b64_tr_b16 v[140:141], v158 offset:8192
    ds_read_b64_tr_b16 v[142:143], v158 offset:8704
    s_add_u32 m0, s56, 4096
    s_add_u32 s3, s59, 57344
    buffer_load_dwordx4 v160, s[20:23], s3 offen lds
    s_setprio 1
    v_mfma_f32_32x32x16_bf16 v[84:99], v[144:147], v[136:139], v[84:99]
    s_setprio 0
    ds_read_b64_tr_b16 v[144:145], v158 offset:10240
    ds_read_b64_tr_b16 v[146:147], v158 offset:10752
    s_add_u32 m0, s56, 5120
    s_add_u32 s3, s59, 86016
    buffer_load_dwordx4 v160, s[20:23], s3 offen lds
    v_mfma_f32_32x32x16_bf16 v[100:115], v[148:151], v[136:139], v[100:115]
    ds_read_b64_tr_b16 v[148:149], v159 offset:8192
    ds_read_b64_tr_b16 v[150:151], v159 offset:8704
    s_add_u32 m0, s56, 6144
    s_add_u32 s3, s59, 57344
    buffer_load_dwordx4 v160, s[24:27], s3 offen lds
    s_setprio 1
    v_mfma_f32_32x32x16_bf16 v[116:131], v[152:155], v[136:139], v[116:131]
    s_setprio 0
    ds_read_b64_tr_b16 v[152:153], v159 offset:10240
    ds_read_b64_tr_b16 v[154:155], v159 offset:10752
    ds_read_b128 v[136:139], v157 offset:4096
    s_add_u32 m0, s56, 7168
    s_add_u32 s3, s59, 86016
    buffer_load_dwordx4 v160, s[24:27], s3 offen lds
    s_waitcnt lgkmcnt(7)
    v_mfma_f32_32x32x16_bf16 v[4:19], v[140:143], v[132:135], v[4:19]
    s_waitcnt lgkmcnt(5)
    s_setprio 1
    v_mfma_f32_32x32x16_bf16 v[20:35], v[144:147], v[132:135], v[20:35]
    s_setprio 0
    s_waitcnt lgkmcnt(3)
    v_mfma_f32_32x32x16_bf16 v[36:51], v[148:151], v[132:135], v[36:51]
    s_waitcnt lgkmcnt(1)
    s_setprio 1
    v_mfma_f32_32x32x16_bf16 v[52:67], v[152:155], v[132:135], v[52:67]
    s_setprio 0
    s_waitcnt vmcnt(4)
    s_add_u32 s61, s4, 6
    s_and_b32 s61, s61, 7
    s_lshl_b32 s61, s61, 13
    v_add_u32 v165, s61, v156
    ds_read_b128 v[132:135], v165 offset:0
    s_waitcnt lgkmcnt(1)
    v_mfma_f32_32x32x16_bf16 v[68:83], v[140:143], v[136:139], v[68:83]
    ds_read_b64_tr_b16 v[140:141], v158 offset:0
    ds_read_b64_tr_b16 v[142:143], v158 offset:512
    s_add_u32 m0, s56, 8192
    s_add_u32 s3, s59, 114688
    buffer_load_dwordx4 v160, s[20:23], s3 offen lds
    s_setprio 1
    v_mfma_f32_32x32x16_bf16 v[84:99], v[144:147], v[136:139], v[84:99]
    s_setprio 0
    ds_read_b64_tr_b16 v[144:145], v158 offset:2048
    ds_read_b64_tr_b16 v[146:147], v158 offset:2560
    s_add_u32 m0, s56, 9216
    s_add_u32 s3, s59, 143360
    buffer_load_dwordx4 v160, s[20:23], s3 offen lds
    v_mfma_f32_32x32x16_bf16 v[100:115], v[148:151], v[136:139], v[100:115]
    ds_read_b64_tr_b16 v[148:149], v159 offset:0
    ds_read_b64_tr_b16 v[150:151], v159 offset:512
    s_add_u32 m0, s56, 10240
    s_add_u32 s3, s59, 114688
    buffer_load_dwordx4 v160, s[24:27], s3 offen lds
    s_setprio 1
    v_mfma_f32_32x32x16_bf16 v[116:131], v[152:155], v[136:139], v[116:131]
    s_setprio 0
    ds_read_b64_tr_b16 v[152:153], v159 offset:2048
    ds_read_b64_tr_b16 v[154:155], v159 offset:2560
    ds_read_b128 v[136:139], v165 offset:4096
    s_add_u32 m0, s56, 11264
    s_add_u32 s3, s59, 143360
    buffer_load_dwordx4 v160, s[24:27], s3 offen lds
    s_waitcnt lgkmcnt(7)
    v_mfma_f32_32x32x16_bf16 v[4:19], v[140:143], v[132:135], v[4:19]
    s_waitcnt lgkmcnt(5)
    s_setprio 1
    v_mfma_f32_32x32x16_bf16 v[20:35], v[144:147], v[132:135], v[20:35]
    s_setprio 0
    s_waitcnt lgkmcnt(3)
    v_mfma_f32_32x32x16_bf16 v[36:51], v[148:151], v[132:135], v[36:51]
    s_waitcnt lgkmcnt(1)
    s_setprio 1
    v_mfma_f32_32x32x16_bf16 v[52:67], v[152:155], v[132:135], v[52:67]
    s_setprio 0
    s_waitcnt vmcnt(4)
    v_xor_b32 v157, 32, v165
    ds_read_b128 v[132:135], v157 offset:0
    s_waitcnt lgkmcnt(1)
    v_mfma_f32_32x32x16_bf16 v[68:83], v[140:143], v[136:139], v[68:83]
    ds_read_b64_tr_b16 v[140:141], v158 offset:4096
    ds_read_b64_tr_b16 v[142:143], v158 offset:4608
    s_add_u32 m0, s56, 0
    s_add_u32 s3, s59, 172032
    buffer_load_dwordx4 v160, s[20:23], s3 offen lds
    s_setprio 1
    v_mfma_f32_32x32x16_bf16 v[84:99], v[144:147], v[136:139], v[84:99]
    s_setprio 0
    ds_read_b64_tr_b16 v[144:145], v158 offset:6144
    ds_read_b64_tr_b16 v[146:147], v158 offset:6656
    s_add_u32 m0, s56, 1024
    s_add_u32 s3, s59, 200704
    buffer_load_dwordx4 v160, s[20:23], s3 offen lds
    v_mfma_f32_32x32x16_bf16 v[100:115], v[148:151], v[136:139], v[100:115]
    ds_read_b64_tr_b16 v[148:149], v159 offset:4096
    ds_read_b64_tr_b16 v[150:151], v159 offset:4608
    s_add_u32 m0, s56, 2048
    s_add_u32 s3, s59, 172032
    buffer_load_dwordx4 v160, s[24:27], s3 offen lds
    s_setprio 1
    v_mfma_f32_32x32x16_bf16 v[116:131], v[152:155], v[136:139], v[116:131]
    s_setprio 0
    ds_read_b64_tr_b16 v[152:153], v159 offset:6144
    ds_read_b64_tr_b16 v[154:155], v159 offset:6656
    ds_read_b128 v[136:139], v157 offset:4096
    s_add_u32 m0, s56, 3072
    s_add_u32 s3, s59, 200704
    buffer_load_dwordx4 v160, s[24:27], s3 offen lds
    s_waitcnt lgkmcnt(7)
    v_mfma_f32_32x32x16_bf16 v[4:19], v[140:143], v[132:135], v[4:19]
    s_waitcnt lgkmcnt(5)
    s_setprio 1
    v_mfma_f32_32x32x16_bf16 v[20:35], v[144:147], v[132:135], v[20:35]
    s_setprio 0
    s_waitcnt lgkmcnt(3)
    v_mfma_f32_32x32x16_bf16 v[36:51], v[148:151], v[132:135], v[36:51]
    s_waitcnt lgkmcnt(1)
    s_setprio 1
    v_mfma_f32_32x32x16_bf16 v[52:67], v[152:155], v[132:135], v[52:67]
    s_setprio 0
    s_waitcnt vmcnt(4)
    v_xor_b32 v157, 64, v165
    ds_read_b128 v[132:135], v157 offset:0
    s_waitcnt lgkmcnt(1)
    v_mfma_f32_32x32x16_bf16 v[68:83], v[140:143], v[136:139], v[68:83]
    ds_read_b64_tr_b16 v[140:141], v158 offset:8192
    ds_read_b64_tr_b16 v[142:143], v158 offset:8704
    s_add_u32 s48, s4, 7
    s_and_b32 s48, s48, 7
    s_mul_i32 s60, s48, 229376
    s_add_u32 s60, s60, s55
    s_add_u32 m0, s56, 4096
    s_add_u32 s3, s60, 0
    buffer_load_dwordx4 v160, s[20:23], s3 offen lds
    s_setprio 1
    v_mfma_f32_32x32x16_bf16 v[84:99], v[144:147], v[136:139], v[84:99]
    s_setprio 0
    ds_read_b64_tr_b16 v[144:145], v158 offset:10240
    ds_read_b64_tr_b16 v[146:147], v158 offset:10752
    s_add_u32 m0, s56, 5120
    s_add_u32 s3, s60, 28672
    buffer_load_dwordx4 v160, s[20:23], s3 offen lds
    v_mfma_f32_32x32x16_bf16 v[100:115], v[148:151], v[136:139], v[100:115]
    ds_read_b64_tr_b16 v[148:149], v159 offset:8192
    ds_read_b64_tr_b16 v[150:151], v159 offset:8704
    s_add_u32 m0, s56, 6144
    s_add_u32 s3, s60, 0
    buffer_load_dwordx4 v160, s[24:27], s3 offen lds
    s_setprio 1
    v_mfma_f32_32x32x16_bf16 v[116:131], v[152:155], v[136:139], v[116:131]
    s_setprio 0
    ds_read_b64_tr_b16 v[152:153], v159 offset:10240
    ds_read_b64_tr_b16 v[154:155], v159 offset:10752
    ds_read_b128 v[136:139], v157 offset:4096
    s_add_u32 m0, s56, 7168
    s_add_u32 s3, s60, 28672
    buffer_load_dwordx4 v160, s[24:27], s3 offen lds
    s_waitcnt lgkmcnt(7)
    v_mfma_f32_32x32x16_bf16 v[4:19], v[140:143], v[132:135], v[4:19]
    s_waitcnt lgkmcnt(5)
    s_setprio 1
    v_mfma_f32_32x32x16_bf16 v[20:35], v[144:147], v[132:135], v[20:35]
    s_setprio 0
    s_waitcnt lgkmcnt(3)
    v_mfma_f32_32x32x16_bf16 v[36:51], v[148:151], v[132:135], v[36:51]
    s_waitcnt lgkmcnt(1)
    s_setprio 1
    v_mfma_f32_32x32x16_bf16 v[52:67], v[152:155], v[132:135], v[52:67]
    s_setprio 0
    s_waitcnt vmcnt(4)
    v_xor_b32 v157, 96, v165
    ds_read_b128 v[132:135], v157 offset:0
    s_waitcnt lgkmcnt(1)
    v_mfma_f32_32x32x16_bf16 v[68:83], v[140:143], v[136:139], v[68:83]
    ds_read_b64_tr_b16 v[140:141], v158 offset:0
    ds_read_b64_tr_b16 v[142:143], v158 offset:512
    s_add_u32 m0, s56, 8192
    s_add_u32 s3, s60, 57344
    buffer_load_dwordx4 v160, s[20:23], s3 offen lds
    s_setprio 1
    v_mfma_f32_32x32x16_bf16 v[84:99], v[144:147], v[136:139], v[84:99]
    s_setprio 0
    ds_read_b64_tr_b16 v[144:145], v158 offset:2048
    ds_read_b64_tr_b16 v[146:147], v158 offset:2560
    s_add_u32 m0, s56, 9216
    s_add_u32 s3, s60, 86016
    buffer_load_dwordx4 v160, s[20:23], s3 offen lds
    v_mfma_f32_32x32x16_bf16 v[100:115], v[148:151], v[136:139], v[100:115]
    ds_read_b64_tr_b16 v[148:149], v159 offset:0
    ds_read_b64_tr_b16 v[150:151], v159 offset:512
    s_add_u32 m0, s56, 10240
    s_add_u32 s3, s60, 57344
    buffer_load_dwordx4 v160, s[24:27], s3 offen lds
    s_setprio 1
    v_mfma_f32_32x32x16_bf16 v[116:131], v[152:155], v[136:139], v[116:131]
    s_setprio 0
    ds_read_b64_tr_b16 v[152:153], v159 offset:2048
    ds_read_b64_tr_b16 v[154:155], v159 offset:2560
    ds_read_b128 v[136:139], v157 offset:4096
    s_add_u32 m0, s56, 11264
    s_add_u32 s3, s60, 86016
    buffer_load_dwordx4 v160, s[24:27], s3 offen lds
    s_waitcnt lgkmcnt(7)
    v_mfma_f32_32x32x16_bf16 v[4:19], v[140:143], v[132:135], v[4:19]
    s_waitcnt lgkmcnt(5)
    s_setprio 1
    v_mfma_f32_32x32x16_bf16 v[20:35], v[144:147], v[132:135], v[20:35]
    s_setprio 0
    s_waitcnt lgkmcnt(3)
    v_mfma_f32_32x32x16_bf16 v[36:51], v[148:151], v[132:135], v[36:51]
    s_waitcnt lgkmcnt(1)
    s_setprio 1
    v_mfma_f32_32x32x16_bf16 v[52:67], v[152:155], v[132:135], v[52:67]
    s_setprio 0
    s_waitcnt vmcnt(4)
    s_add_u32 s61, s4, 7
    s_and_b32 s61, s61, 7
    s_lshl_b32 s61, s61, 13
    v_add_u32 v165, s61, v156
    ds_read_b128 v[132:135], v165 offset:0
    s_waitcnt lgkmcnt(1)
    v_mfma_f32_32x32x16_bf16 v[68:83], v[140:143], v[136:139], v[68:83]
    ds_read_b64_tr_b16 v[140:141], v158 offset:4096
    ds_read_b64_tr_b16 v[142:143], v158 offset:4608
    s_add_u32 m0, s56, 0
    s_add_u32 s3, s60, 114688
    buffer_load_dwordx4 v160, s[20:23], s3 offen lds
    s_setprio 1
    v_mfma_f32_32x32x16_bf16 v[84:99], v[144:147], v[136:139], v[84:99]
    s_setprio 0
    ds_read_b64_tr_b16 v[144:145], v158 offset:6144
    ds_read_b64_tr_b16 v[146:147], v158 offset:6656
    s_add_u32 m0, s56, 1024
    s_add_u32 s3, s60, 143360
    buffer_load_dwordx4 v160, s[20:23], s3 offen lds
    v_mfma_f32_32x32x16_bf16 v[100:115], v[148:151], v[136:139], v[100:115]
    ds_read_b64_tr_b16 v[148:149], v159 offset:4096
    ds_read_b64_tr_b16 v[150:151], v159 offset:4608
    s_add_u32 m0, s56, 2048
    s_add_u32 s3, s60, 114688
    buffer_load_dwordx4 v160, s[24:27], s3 offen lds
    s_setprio 1
    v_mfma_f32_32x32x16_bf16 v[116:131], v[152:155], v[136:139], v[116:131]
    s_setprio 0
    ds_read_b64_tr_b16 v[152:153], v159 offset:6144
    ds_read_b64_tr_b16 v[154:155], v159 offset:6656
    ds_read_b128 v[136:139], v165 offset:4096
    s_add_u32 m0, s56, 3072
    s_add_u32 s3, s60, 143360
    buffer_load_dwordx4 v160, s[24:27], s3 offen lds
    s_waitcnt lgkmcnt(7)
    v_mfma_f32_32x32x16_bf16 v[4:19], v[140:143], v[132:135], v[4:19]
    s_waitcnt lgkmcnt(5)
    s_setprio 1
    v_mfma_f32_32x32x16_bf16 v[20:35], v[144:147], v[132:135], v[20:35]
    s_setprio 0
    s_waitcnt lgkmcnt(3)
    v_mfma_f32_32x32x16_bf16 v[36:51], v[148:151], v[132:135], v[36:51]
    s_waitcnt lgkmcnt(1)
    s_setprio 1
    v_mfma_f32_32x32x16_bf16 v[52:67], v[152:155], v[132:135], v[52:67]
    s_setprio 0
    s_waitcnt vmcnt(4)
    v_xor_b32 v157, 32, v165
    ds_read_b128 v[132:135], v157 offset:0
    s_waitcnt lgkmcnt(1)
    v_mfma_f32_32x32x16_bf16 v[68:83], v[140:143], v[136:139], v[68:83]
    ds_read_b64_tr_b16 v[140:141], v158 offset:8192
    ds_read_b64_tr_b16 v[142:143], v158 offset:8704
    s_add_u32 m0, s56, 4096
    s_add_u32 s3, s60, 172032
    buffer_load_dwordx4 v160, s[20:23], s3 offen lds
    s_setprio 1
    v_mfma_f32_32x32x16_bf16 v[84:99], v[144:147], v[136:139], v[84:99]
    s_setprio 0
    ds_read_b64_tr_b16 v[144:145], v158 offset:10240
    ds_read_b64_tr_b16 v[146:147], v158 offset:10752
    s_add_u32 m0, s56, 5120
    s_add_u32 s3, s60, 200704
    buffer_load_dwordx4 v160, s[20:23], s3 offen lds
    v_mfma_f32_32x32x16_bf16 v[100:115], v[148:151], v[136:139], v[100:115]
    ds_read_b64_tr_b16 v[148:149], v159 offset:8192
    ds_read_b64_tr_b16 v[150:151], v159 offset:8704
    s_add_u32 m0, s56, 6144
    s_add_u32 s3, s60, 172032
    buffer_load_dwordx4 v160, s[24:27], s3 offen lds
    s_setprio 1
    v_mfma_f32_32x32x16_bf16 v[116:131], v[152:155], v[136:139], v[116:131]
    s_setprio 0
    ds_read_b64_tr_b16 v[152:153], v159 offset:10240
    ds_read_b64_tr_b16 v[154:155], v159 offset:10752
    ds_read_b128 v[136:139], v157 offset:4096
    s_add_u32 m0, s56, 7168
    s_add_u32 s3, s60, 200704
    buffer_load_dwordx4 v160, s[24:27], s3 offen lds
    s_waitcnt lgkmcnt(7)
    v_mfma_f32_32x32x16_bf16 v[4:19], v[140:143], v[132:135], v[4:19]
    s_waitcnt lgkmcnt(5)
    s_setprio 1
    v_mfma_f32_32x32x16_bf16 v[20:35], v[144:147], v[132:135], v[20:35]
    s_setprio 0
    s_waitcnt lgkmcnt(3)
    v_mfma_f32_32x32x16_bf16 v[36:51], v[148:151], v[132:135], v[36:51]
    s_waitcnt lgkmcnt(1)
    s_setprio 1
    v_mfma_f32_32x32x16_bf16 v[52:67], v[152:155], v[132:135], v[52:67]
    s_setprio 0
    s_waitcnt vmcnt(4)
    v_xor_b32 v157, 64, v165
    ds_read_b128 v[132:135], v157 offset:0
    s_waitcnt lgkmcnt(1)
    v_mfma_f32_32x32x16_bf16 v[68:83], v[140:143], v[136:139], v[68:83]
    ds_read_b64_tr_b16 v[140:141], v158 offset:0
    ds_read_b64_tr_b16 v[142:143], v158 offset:512
    s_setprio 1
    v_mfma_f32_32x32x16_bf16 v[84:99], v[144:147], v[136:139], v[84:99]
    s_setprio 0
    ds_read_b64_tr_b16 v[144:145], v158 offset:2048
    ds_read_b64_tr_b16 v[146:147], v158 offset:2560
    v_mfma_f32_32x32x16_bf16 v[100:115], v[148:151], v[136:139], v[100:115]
    ds_read_b64_tr_b16 v[148:149], v159 offset:0
    ds_read_b64_tr_b16 v[150:151], v159 offset:512
    s_setprio 1
    v_mfma_f32_32x32x16_bf16 v[116:131], v[152:155], v[136:139], v[116:131]
    s_setprio 0
    ds_read_b64_tr_b16 v[152:153], v159 offset:2048
    ds_read_b64_tr_b16 v[154:155], v159 offset:2560
    ds_read_b128 v[136:139], v157 offset:4096
    s_waitcnt lgkmcnt(7)
    v_mfma_f32_32x32x16_bf16 v[4:19], v[140:143], v[132:135], v[4:19]
    s_waitcnt lgkmcnt(5)
    s_setprio 1
    v_mfma_f32_32x32x16_bf16 v[20:35], v[144:147], v[132:135], v[20:35]
    s_setprio 0
    s_waitcnt lgkmcnt(3)
    v_mfma_f32_32x32x16_bf16 v[36:51], v[148:151], v[132:135], v[36:51]
    s_waitcnt lgkmcnt(1)
    s_setprio 1
    v_mfma_f32_32x32x16_bf16 v[52:67], v[152:155], v[132:135], v[52:67]
    s_setprio 0
    s_waitcnt vmcnt(0)
    v_xor_b32 v157, 96, v165
    ds_read_b128 v[132:135], v157 offset:0
    s_waitcnt lgkmcnt(1)
    v_mfma_f32_32x32x16_bf16 v[68:83], v[140:143], v[136:139], v[68:83]
    ds_read_b64_tr_b16 v[140:141], v158 offset:4096
    ds_read_b64_tr_b16 v[142:143], v158 offset:4608
    s_setprio 1
    v_mfma_f32_32x32x16_bf16 v[84:99], v[144:147], v[136:139], v[84:99]
    s_setprio 0
    ds_read_b64_tr_b16 v[144:145], v158 offset:6144
    ds_read_b64_tr_b16 v[146:147], v158 offset:6656
    v_mfma_f32_32x32x16_bf16 v[100:115], v[148:151], v[136:139], v[100:115]
    ds_read_b64_tr_b16 v[148:149], v159 offset:4096
    ds_read_b64_tr_b16 v[150:151], v159 offset:4608
    s_setprio 1
    v_mfma_f32_32x32x16_bf16 v[116:131], v[152:155], v[136:139], v[116:131]
    s_setprio 0
    ds_read_b64_tr_b16 v[152:153], v159 offset:6144
    ds_read_b64_tr_b16 v[154:155], v159 offset:6656
    ds_read_b128 v[136:139], v157 offset:4096
    s_waitcnt lgkmcnt(7)
    v_mfma_f32_32x32x16_bf16 v[4:19], v[140:143], v[132:135], v[4:19]
    s_waitcnt lgkmcnt(5)
    s_setprio 1
    v_mfma_f32_32x32x16_bf16 v[20:35], v[144:147], v[132:135], v[20:35]
    s_setprio 0
    s_waitcnt lgkmcnt(3)
    v_mfma_f32_32x32x16_bf16 v[36:51], v[148:151], v[132:135], v[36:51]
    s_waitcnt lgkmcnt(1)
    s_setprio 1
    v_mfma_f32_32x32x16_bf16 v[52:67], v[152:155], v[132:135], v[52:67]
    s_setprio 0
    s_waitcnt lgkmcnt(0)
    v_mfma_f32_32x32x16_bf16 v[68:83], v[140:143], v[136:139], v[68:83]
    s_setprio 1
    v_mfma_f32_32x32x16_bf16 v[84:99], v[144:147], v[136:139], v[84:99]
    s_setprio 0
    v_mfma_f32_32x32x16_bf16 v[100:115], v[148:151], v[136:139], v[100:115]
    s_setprio 1
    v_mfma_f32_32x32x16_bf16 v[116:131], v[152:155], v[136:139], v[116:131]
    s_setprio 0
    s_setprio 1
    v_mov_b32 v162, 155712
    v_mov_b32 v163, 1
    s_mov_b64 exec, 1
    ds_add_u32 v162, v163 offset:0
    s_mov_b64 exec, -1
    s_lshl_b32 s48, s4, 1
    s_mul_i32 s48, s48, 114688
    s_lshl_b32 s49, s58, 14
    s_add_u32 s48, s48, s49
    s_lshl_b32 s49, s54, 12
    s_add_u32 s48, s48, s49
    s_add_u32 s57, s48, 9437184
    v_lshlrev_b32 v160, 4, v1
    s_nop 3
    v_max_f32 v4, 0, v4
    v_max_f32 v5, 0, v5
    v_max_f32 v6, 0, v6
    v_max_f32 v7, 0, v7
    v_max_f32 v8, 0, v8
    v_max_f32 v9, 0, v9
    v_max_f32 v10, 0, v10
    v_max_f32 v11, 0, v11
    v_max_f32 v12, 0, v12
    v_max_f32 v13, 0, v13
    v_max_f32 v14, 0, v14
    v_max_f32 v15, 0, v15
    v_max_f32 v16, 0, v16
    v_max_f32 v17, 0, v17
    v_max_f32 v18, 0, v18
    v_max_f32 v19, 0, v19
    v_mul_f32 v4, v4, v20
    v_mul_f32 v5, v5, v21
    v_mul_f32 v6, v6, v22
    v_mul_f32 v7, v7, v23
    v_mul_f32 v8, v8, v24
    v_mul_f32 v9, v9, v25
    v_mul_f32 v10, v10, v26
    v_mul_f32 v11, v11, v27
    v_mul_f32 v12, v12, v28
    v_mul_f32 v13, v13, v29
    v_mul_f32 v14, v14, v30
    v_mul_f32 v15, v15, v31
    v_mul_f32 v16, v16, v32
    v_mul_f32 v17, v17, v33
    v_mul_f32 v18, v18, v34
    v_mul_f32 v19, v19, v35
    v_cvt_pk_bf16_f32 v20, v4, v5
    v_cvt_pk_bf16_f32 v21, v6, v7
    v_cvt_pk_bf16_f32 v22, v8, v9
    v_cvt_pk_bf16_f32 v23, v10, v11
    v_cvt_pk_bf16_f32 v24, v12, v13
    v_cvt_pk_bf16_f32 v25, v14, v15
    v_cvt_pk_bf16_f32 v26, v16, v17
    v_cvt_pk_bf16_f32 v27, v18, v19
    s_add_u32 s3, s57, 0
    buffer_store_dwordx4 v[20:23], v160, s[40:43], s3 offen sc1
    s_add_u32 s3, s57, 1024
    buffer_store_dwordx4 v[24:27], v160, s[40:43], s3 offen sc1
    v_max_f32 v36, 0, v36
    v_max_f32 v37, 0, v37
    v_max_f32 v38, 0, v38
    v_max_f32 v39, 0, v39
    v_max_f32 v40, 0, v40
    v_max_f32 v41, 0, v41
    v_max_f32 v42, 0, v42
    v_max_f32 v43, 0, v43
    v_max_f32 v44, 0, v44
    v_max_f32 v45, 0, v45
    v_max_f32 v46, 0, v46
    v_max_f32 v47, 0, v47
    v_max_f32 v48, 0, v48
    v_max_f32 v49, 0, v49
    v_max_f32 v50, 0, v50
    v_max_f32 v51, 0, v51
    v_mul_f32 v36, v36, v52
    v_mul_f32 v37, v37, v53
    v_mul_f32 v38, v38, v54
    v_mul_f32 v39, v39, v55
    v_mul_f32 v40, v40, v56
    v_mul_f32 v41, v41, v57
    v_mul_f32 v42, v42, v58
    v_mul_f32 v43, v43, v59
    v_mul_f32 v44, v44, v60
    v_mul_f32 v45, v45, v61
    v_mul_f32 v46, v46, v62
    v_mul_f32 v47, v47, v63
    v_mul_f32 v48, v48, v64
    v_mul_f32 v49, v49, v65
    v_mul_f32 v50, v50, v66
    v_mul_f32 v51, v51, v67
    v_cvt_pk_bf16_f32 v52, v36, v37
    v_cvt_pk_bf16_f32 v53, v38, v39
    v_cvt_pk_bf16_f32 v54, v40, v41
    v_cvt_pk_bf16_f32 v55, v42, v43
    v_cvt_pk_bf16_f32 v56, v44, v45
    v_cvt_pk_bf16_f32 v57, v46, v47
    v_cvt_pk_bf16_f32 v58, v48, v49
    v_cvt_pk_bf16_f32 v59, v50, v51
    s_add_u32 s3, s57, 2048
    buffer_store_dwordx4 v[52:55], v160, s[40:43], s3 offen sc1
    s_add_u32 s3, s57, 3072
    buffer_store_dwordx4 v[56:59], v160, s[40:43], s3 offen sc1
    v_max_f32 v68, 0, v68
    v_max_f32 v69, 0, v69
    v_max_f32 v70, 0, v70
    v_max_f32 v71, 0, v71
    v_max_f32 v72, 0, v72
    v_max_f32 v73, 0, v73
    v_max_f32 v74, 0, v74
    v_max_f32 v75, 0, v75
    v_max_f32 v76, 0, v76
    v_max_f32 v77, 0, v77
    v_max_f32 v78, 0, v78
    v_max_f32 v79, 0, v79
    v_max_f32 v80, 0, v80
    v_max_f32 v81, 0, v81
    v_max_f32 v82, 0, v82
    v_max_f32 v83, 0, v83
    v_mul_f32 v68, v68, v84
    v_mul_f32 v69, v69, v85
    v_mul_f32 v70, v70, v86
    v_mul_f32 v71, v71, v87
    v_mul_f32 v72, v72, v88
    v_mul_f32 v73, v73, v89
    v_mul_f32 v74, v74, v90
    v_mul_f32 v75, v75, v91
    v_mul_f32 v76, v76, v92
    v_mul_f32 v77, v77, v93
    v_mul_f32 v78, v78, v94
    v_mul_f32 v79, v79, v95
    v_mul_f32 v80, v80, v96
    v_mul_f32 v81, v81, v97
    v_mul_f32 v82, v82, v98
    v_mul_f32 v83, v83, v99
    v_cvt_pk_bf16_f32 v84, v68, v69
    v_cvt_pk_bf16_f32 v85, v70, v71
    v_cvt_pk_bf16_f32 v86, v72, v73
    v_cvt_pk_bf16_f32 v87, v74, v75
    v_cvt_pk_bf16_f32 v88, v76, v77
    v_cvt_pk_bf16_f32 v89, v78, v79
    v_cvt_pk_bf16_f32 v90, v80, v81
    v_cvt_pk_bf16_f32 v91, v82, v83
    s_add_u32 s3, s57, 114688
    buffer_store_dwordx4 v[84:87], v160, s[40:43], s3 offen sc1
    s_add_u32 s3, s57, 115712
    buffer_store_dwordx4 v[88:91], v160, s[40:43], s3 offen sc1
    v_max_f32 v100, 0, v100
    v_max_f32 v101, 0, v101
    v_max_f32 v102, 0, v102
    v_max_f32 v103, 0, v103
    v_max_f32 v104, 0, v104
    v_max_f32 v105, 0, v105
    v_max_f32 v106, 0, v106
    v_max_f32 v107, 0, v107
    v_max_f32 v108, 0, v108
    v_max_f32 v109, 0, v109
    v_max_f32 v110, 0, v110
    v_max_f32 v111, 0, v111
    v_max_f32 v112, 0, v112
    v_max_f32 v113, 0, v113
    v_max_f32 v114, 0, v114
    v_max_f32 v115, 0, v115
    v_mul_f32 v100, v100, v116
    v_mul_f32 v101, v101, v117
    v_mul_f32 v102, v102, v118
    v_mul_f32 v103, v103, v119
    v_mul_f32 v104, v104, v120
    v_mul_f32 v105, v105, v121
    v_mul_f32 v106, v106, v122
    v_mul_f32 v107, v107, v123
    v_mul_f32 v108, v108, v124
    v_mul_f32 v109, v109, v125
    v_mul_f32 v110, v110, v126
    v_mul_f32 v111, v111, v127
    v_mul_f32 v112, v112, v128
    v_mul_f32 v113, v113, v129
    v_mul_f32 v114, v114, v130
    v_mul_f32 v115, v115, v131
    v_cvt_pk_bf16_f32 v116, v100, v101
    v_cvt_pk_bf16_f32 v117, v102, v103
    v_cvt_pk_bf16_f32 v118, v104, v105
    v_cvt_pk_bf16_f32 v119, v106, v107
    v_cvt_pk_bf16_f32 v120, v108, v109
    v_cvt_pk_bf16_f32 v121, v110, v111
    v_cvt_pk_bf16_f32 v122, v112, v113
    v_cvt_pk_bf16_f32 v123, v114, v115
    s_add_u32 s3, s57, 116736
    buffer_store_dwordx4 v[116:119], v160, s[40:43], s3 offen sc1
    s_add_u32 s3, s57, 117760
    buffer_store_dwordx4 v[120:123], v160, s[40:43], s3 offen sc1
    s_lshl_b32 s48, s4, 5
    s_lshl_b32 s49, s58, 2
    s_add_u32 s48, s48, s49
    s_add_u32 s48, s48, s54
    s_lshl_b32 s48, s48, 6
    s_add_u32 s48, s48, 8519680
    s_waitcnt vmcnt(0)
    v_mov_b32 v163, 0
    v_mov_b32 v164, s7
    s_mov_b64 exec, 1
    buffer_store_dword v164, v163, s[40:43], s48 offen sc1
    s_mov_b64 exec, -1
    s_branch gated_mix__mha_block__glu_gated_reglu__prompt_kernel_final
gated_mix__mha_block__glu_gated_reglu__prompt_kernel_gate:
    s_cmp_ge_u32 s6, 10
    s_cbranch_scc1 gated_mix__mha_block__glu_gated_reglu__prompt_kernel_gate_done
    v_lshrrev_b32 v4, 5, v1
    v_lshlrev_b32 v4, 4, v4
    buffer_load_dwordx4 v[12:15], v4, s[32:35], 0 offen offset:0
    buffer_load_dwordx4 v[16:19], v4, s[32:35], 0 offen offset:32
    buffer_load_dwordx4 v[20:23], v4, s[32:35], 0 offen offset:64
    buffer_load_dwordx4 v[24:27], v4, s[32:35], 0 offen offset:96
    buffer_load_dwordx4 v[28:31], v4, s[32:35], 0 offen offset:128
    buffer_load_dwordx4 v[32:35], v4, s[32:35], 0 offen offset:160
    buffer_load_dwordx4 v[36:39], v4, s[32:35], 0 offen offset:192
    buffer_load_dwordx4 v[40:43], v4, s[32:35], 0 offen offset:224
    buffer_load_dwordx4 v[44:47], v4, s[32:35], 0 offen offset:256
    buffer_load_dwordx4 v[48:51], v4, s[32:35], 0 offen offset:288
    buffer_load_dwordx4 v[52:55], v4, s[32:35], 0 offen offset:320
    buffer_load_dwordx4 v[56:59], v4, s[32:35], 0 offen offset:352
    buffer_load_dwordx4 v[60:63], v4, s[32:35], 0 offen offset:384
    buffer_load_dwordx4 v[64:67], v4, s[32:35], 0 offen offset:416
    buffer_load_dwordx4 v[68:71], v4, s[32:35], 0 offen offset:448
    buffer_load_dwordx4 v[72:75], v4, s[32:35], 0 offen offset:480
    buffer_load_dwordx4 v[76:79], v4, s[32:35], 0 offen offset:512
    buffer_load_dwordx4 v[80:83], v4, s[32:35], 0 offen offset:544
    buffer_load_dwordx4 v[84:87], v4, s[32:35], 0 offen offset:576
    buffer_load_dwordx4 v[88:91], v4, s[32:35], 0 offen offset:608
    buffer_load_dwordx4 v[92:95], v4, s[32:35], 0 offen offset:640
    buffer_load_dwordx4 v[96:99], v4, s[32:35], 0 offen offset:672
    buffer_load_dwordx4 v[100:103], v4, s[32:35], 0 offen offset:704
    buffer_load_dwordx4 v[104:107], v4, s[32:35], 0 offen offset:736
    buffer_load_dwordx4 v[108:111], v4, s[32:35], 0 offen offset:768
    buffer_load_dwordx4 v[112:115], v4, s[32:35], 0 offen offset:800
    buffer_load_dwordx4 v[116:119], v4, s[32:35], 0 offen offset:832
    buffer_load_dwordx4 v[120:123], v4, s[32:35], 0 offen offset:864
    buffer_load_dwordx4 v[124:127], v4, s[32:35], 0 offen offset:896
    buffer_load_dwordx4 v[128:131], v4, s[32:35], 0 offen offset:928
    buffer_load_dwordx4 v[132:135], v4, s[32:35], 0 offen offset:960
    buffer_load_dwordx4 v[136:139], v4, s[32:35], 0 offen offset:992
    v_and_b32 v140, 31, v1
    v_lshrrev_b32 v141, 3, v140
    v_lshlrev_b32 v141, 10, v141
    v_and_b32 v142, 7, v140
    v_lshlrev_b32 v142, 7, v142
    v_add_u32 v141, v141, v142
    v_lshrrev_b32 v142, 1, v140
    v_and_b32 v142, 7, v142
    v_lshrrev_b32 v143, 5, v1
    v_xor_b32 v142, v142, v143
    v_lshlrev_b32 v142, 4, v142
    v_add_u32 v6, v141, v142
    s_and_b32 s48, s6, 1
    s_lshl_b32 s48, s48, 12
    v_add_u32 v6, s48, v6
    v_xor_b32 v7, 32, v6
    v_xor_b32 v8, 64, v6
    v_xor_b32 v9, 96, v6
    v_mov_b32 v10, 0
    v_mov_b32 v11, 0
    s_waitcnt vmcnt(0)
    ds_read_b128 v[140:143], v6 offset:0
    ds_read_b128 v[144:147], v7 offset:0
    ds_read_b128 v[148:151], v8 offset:0
    ds_read_b128 v[152:155], v9 offset:0
    s_waitcnt lgkmcnt(0)
    v_dot2_f32_bf16 v10, v140, v12, v10
    v_dot2_f32_bf16 v11, v141, v13, v11
    v_dot2_f32_bf16 v10, v142, v14, v10
    v_dot2_f32_bf16 v11, v143, v15, v11
    v_dot2_f32_bf16 v10, v144, v16, v10
    v_dot2_f32_bf16 v11, v145, v17, v11
    v_dot2_f32_bf16 v10, v146, v18, v10
    v_dot2_f32_bf16 v11, v147, v19, v11
    v_dot2_f32_bf16 v10, v148, v20, v10
    v_dot2_f32_bf16 v11, v149, v21, v11
    v_dot2_f32_bf16 v10, v150, v22, v10
    v_dot2_f32_bf16 v11, v151, v23, v11
    v_dot2_f32_bf16 v10, v152, v24, v10
    v_dot2_f32_bf16 v11, v153, v25, v11
    v_dot2_f32_bf16 v10, v154, v26, v10
    v_dot2_f32_bf16 v11, v155, v27, v11
    ds_read_b128 v[140:143], v6 offset:8192
    ds_read_b128 v[144:147], v7 offset:8192
    ds_read_b128 v[148:151], v8 offset:8192
    ds_read_b128 v[152:155], v9 offset:8192
    s_waitcnt lgkmcnt(0)
    v_dot2_f32_bf16 v10, v140, v28, v10
    v_dot2_f32_bf16 v11, v141, v29, v11
    v_dot2_f32_bf16 v10, v142, v30, v10
    v_dot2_f32_bf16 v11, v143, v31, v11
    v_dot2_f32_bf16 v10, v144, v32, v10
    v_dot2_f32_bf16 v11, v145, v33, v11
    v_dot2_f32_bf16 v10, v146, v34, v10
    v_dot2_f32_bf16 v11, v147, v35, v11
    v_dot2_f32_bf16 v10, v148, v36, v10
    v_dot2_f32_bf16 v11, v149, v37, v11
    v_dot2_f32_bf16 v10, v150, v38, v10
    v_dot2_f32_bf16 v11, v151, v39, v11
    v_dot2_f32_bf16 v10, v152, v40, v10
    v_dot2_f32_bf16 v11, v153, v41, v11
    v_dot2_f32_bf16 v10, v154, v42, v10
    v_dot2_f32_bf16 v11, v155, v43, v11
    ds_read_b128 v[140:143], v6 offset:16384
    ds_read_b128 v[144:147], v7 offset:16384
    ds_read_b128 v[148:151], v8 offset:16384
    ds_read_b128 v[152:155], v9 offset:16384
    s_waitcnt lgkmcnt(0)
    v_dot2_f32_bf16 v10, v140, v44, v10
    v_dot2_f32_bf16 v11, v141, v45, v11
    v_dot2_f32_bf16 v10, v142, v46, v10
    v_dot2_f32_bf16 v11, v143, v47, v11
    v_dot2_f32_bf16 v10, v144, v48, v10
    v_dot2_f32_bf16 v11, v145, v49, v11
    v_dot2_f32_bf16 v10, v146, v50, v10
    v_dot2_f32_bf16 v11, v147, v51, v11
    v_dot2_f32_bf16 v10, v148, v52, v10
    v_dot2_f32_bf16 v11, v149, v53, v11
    v_dot2_f32_bf16 v10, v150, v54, v10
    v_dot2_f32_bf16 v11, v151, v55, v11
    v_dot2_f32_bf16 v10, v152, v56, v10
    v_dot2_f32_bf16 v11, v153, v57, v11
    v_dot2_f32_bf16 v10, v154, v58, v10
    v_dot2_f32_bf16 v11, v155, v59, v11
    ds_read_b128 v[140:143], v6 offset:24576
    ds_read_b128 v[144:147], v7 offset:24576
    ds_read_b128 v[148:151], v8 offset:24576
    ds_read_b128 v[152:155], v9 offset:24576
    s_waitcnt lgkmcnt(0)
    v_dot2_f32_bf16 v10, v140, v60, v10
    v_dot2_f32_bf16 v11, v141, v61, v11
    v_dot2_f32_bf16 v10, v142, v62, v10
    v_dot2_f32_bf16 v11, v143, v63, v11
    v_dot2_f32_bf16 v10, v144, v64, v10
    v_dot2_f32_bf16 v11, v145, v65, v11
    v_dot2_f32_bf16 v10, v146, v66, v10
    v_dot2_f32_bf16 v11, v147, v67, v11
    v_dot2_f32_bf16 v10, v148, v68, v10
    v_dot2_f32_bf16 v11, v149, v69, v11
    v_dot2_f32_bf16 v10, v150, v70, v10
    v_dot2_f32_bf16 v11, v151, v71, v11
    v_dot2_f32_bf16 v10, v152, v72, v10
    v_dot2_f32_bf16 v11, v153, v73, v11
    v_dot2_f32_bf16 v10, v154, v74, v10
    v_dot2_f32_bf16 v11, v155, v75, v11
    ds_read_b128 v[140:143], v6 offset:32768
    ds_read_b128 v[144:147], v7 offset:32768
    ds_read_b128 v[148:151], v8 offset:32768
    ds_read_b128 v[152:155], v9 offset:32768
    s_waitcnt lgkmcnt(0)
    v_dot2_f32_bf16 v10, v140, v76, v10
    v_dot2_f32_bf16 v11, v141, v77, v11
    v_dot2_f32_bf16 v10, v142, v78, v10
    v_dot2_f32_bf16 v11, v143, v79, v11
    v_dot2_f32_bf16 v10, v144, v80, v10
    v_dot2_f32_bf16 v11, v145, v81, v11
    v_dot2_f32_bf16 v10, v146, v82, v10
    v_dot2_f32_bf16 v11, v147, v83, v11
    v_dot2_f32_bf16 v10, v148, v84, v10
    v_dot2_f32_bf16 v11, v149, v85, v11
    v_dot2_f32_bf16 v10, v150, v86, v10
    v_dot2_f32_bf16 v11, v151, v87, v11
    v_dot2_f32_bf16 v10, v152, v88, v10
    v_dot2_f32_bf16 v11, v153, v89, v11
    v_dot2_f32_bf16 v10, v154, v90, v10
    v_dot2_f32_bf16 v11, v155, v91, v11
    ds_read_b128 v[140:143], v6 offset:40960
    ds_read_b128 v[144:147], v7 offset:40960
    ds_read_b128 v[148:151], v8 offset:40960
    ds_read_b128 v[152:155], v9 offset:40960
    s_waitcnt lgkmcnt(0)
    v_dot2_f32_bf16 v10, v140, v92, v10
    v_dot2_f32_bf16 v11, v141, v93, v11
    v_dot2_f32_bf16 v10, v142, v94, v10
    v_dot2_f32_bf16 v11, v143, v95, v11
    v_dot2_f32_bf16 v10, v144, v96, v10
    v_dot2_f32_bf16 v11, v145, v97, v11
    v_dot2_f32_bf16 v10, v146, v98, v10
    v_dot2_f32_bf16 v11, v147, v99, v11
    v_dot2_f32_bf16 v10, v148, v100, v10
    v_dot2_f32_bf16 v11, v149, v101, v11
    v_dot2_f32_bf16 v10, v150, v102, v10
    v_dot2_f32_bf16 v11, v151, v103, v11
    v_dot2_f32_bf16 v10, v152, v104, v10
    v_dot2_f32_bf16 v11, v153, v105, v11
    v_dot2_f32_bf16 v10, v154, v106, v10
    v_dot2_f32_bf16 v11, v155, v107, v11
    ds_read_b128 v[140:143], v6 offset:49152
    ds_read_b128 v[144:147], v7 offset:49152
    ds_read_b128 v[148:151], v8 offset:49152
    ds_read_b128 v[152:155], v9 offset:49152
    s_waitcnt lgkmcnt(0)
    v_dot2_f32_bf16 v10, v140, v108, v10
    v_dot2_f32_bf16 v11, v141, v109, v11
    v_dot2_f32_bf16 v10, v142, v110, v10
    v_dot2_f32_bf16 v11, v143, v111, v11
    v_dot2_f32_bf16 v10, v144, v112, v10
    v_dot2_f32_bf16 v11, v145, v113, v11
    v_dot2_f32_bf16 v10, v146, v114, v10
    v_dot2_f32_bf16 v11, v147, v115, v11
    v_dot2_f32_bf16 v10, v148, v116, v10
    v_dot2_f32_bf16 v11, v149, v117, v11
    v_dot2_f32_bf16 v10, v150, v118, v10
    v_dot2_f32_bf16 v11, v151, v119, v11
    v_dot2_f32_bf16 v10, v152, v120, v10
    v_dot2_f32_bf16 v11, v153, v121, v11
    v_dot2_f32_bf16 v10, v154, v122, v10
    v_dot2_f32_bf16 v11, v155, v123, v11
    ds_read_b128 v[140:143], v6 offset:57344
    ds_read_b128 v[144:147], v7 offset:57344
    ds_read_b128 v[148:151], v8 offset:57344
    ds_read_b128 v[152:155], v9 offset:57344
    s_waitcnt lgkmcnt(0)
    v_dot2_f32_bf16 v10, v140, v124, v10
    v_dot2_f32_bf16 v11, v141, v125, v11
    v_dot2_f32_bf16 v10, v142, v126, v10
    v_dot2_f32_bf16 v11, v143, v127, v11
    v_dot2_f32_bf16 v10, v144, v128, v10
    v_dot2_f32_bf16 v11, v145, v129, v11
    v_dot2_f32_bf16 v10, v146, v130, v10
    v_dot2_f32_bf16 v11, v147, v131, v11
    v_dot2_f32_bf16 v10, v148, v132, v10
    v_dot2_f32_bf16 v11, v149, v133, v11
    v_dot2_f32_bf16 v10, v150, v134, v10
    v_dot2_f32_bf16 v11, v151, v135, v11
    v_dot2_f32_bf16 v10, v152, v136, v10
    v_dot2_f32_bf16 v11, v153, v137, v11
    v_dot2_f32_bf16 v10, v154, v138, v10
    v_dot2_f32_bf16 v11, v155, v139, v11
    s_nop 2
    v_add_f32 v10, v10, v11
    s_nop 0
    v_mov_b32 v11, v10
    s_nop 1
    v_permlane32_swap_b32 v10, v11
    s_nop 1
    v_add_f32 v10, v10, v11
    v_mul_f32 v10, 0xbfb8aa3b, v10
    v_exp_f32 v10, v10
    s_nop 0
    v_add_f32 v10, 1.0, v10
    v_rcp_f32 v10, v10
    s_lshl_b32 s48, s4, 8
    s_and_b32 s49, s6, 1
    s_lshl_b32 s49, s49, 7
    s_add_u32 s48, s48, s49
    s_add_u32 s48, s48, 8388608
    v_and_b32 v2, 31, v1
    v_lshlrev_b32 v2, 2, v2
    buffer_store_dword v10, v2, s[40:43], s48 offen sc1
    s_lshl_b32 s48, s4, 5
    s_and_b32 s49, s6, 1
    s_add_u32 s48, s48, s49
    s_add_u32 s48, s48, 28
    s_lshl_b32 s48, s48, 6
    s_add_u32 s48, s48, 8519680
    s_waitcnt vmcnt(0)
    v_mov_b32 v2, 0
    v_mov_b32 v3, s7
    s_mov_b64 exec, 1
    buffer_store_dword v3, v2, s[40:43], s48 offen sc1
    s_mov_b64 exec, -1
gated_mix__mha_block__glu_gated_reglu__prompt_kernel_gate_done:
    v_mov_b32 v2, 155712
    v_mov_b32 v3, 1
    s_mov_b64 exec, 1
    ds_add_u32 v2, v3 offset:0
    s_mov_b64 exec, -1
gated_mix__mha_block__glu_gated_reglu__prompt_kernel_final:
    s_sub_u32 s54, s6, 8
    s_and_b32 s55, s54, 1
    s_lshr_b32 s56, s54, 1
    v_lshlrev_b32 v8, 4, v1
    v_lshrrev_b32 v2, 2, v1
    v_and_b32 v2, 4, v2
    v_and_b32 v3, 7, v1
    v_xor_b32 v2, v2, v3
    v_lshlrev_b32 v2, 4, v2
    v_lshrrev_b32 v3, 3, v1
    v_mul_u32_u24 v3, 1024, v3
    v_add_u32 v10, v2, v3
    s_mul_i32 s59, s54, 458752
    s_lshl_b32 s48, s53, 7
    s_add_u32 s59, s59, s48
    s_mul_i32 s61, s54, 12288
    s_add_u32 s61, s61, 65536
    s_lshl_b32 s60, s52, 1
    s_mul_i32 s60, s60, 114688
    s_mul_i32 s48, s54, 28672
    s_add_u32 s60, s60, s48
    s_add_u32 s60, s60, 9437184
    s_and_b32 s63, s52, 3
    s_mul_i32 s63, s63, 7
    s_mul_i32 s48, s53, 4
    s_add_u32 s63, s63, s48
    s_cmp_ge_u32 s63, 28
    s_cselect_b32 s48, 28, 0
    s_sub_u32 s63, s63, s48
    s_add_u32 s64, s63, 0
    s_cmp_ge_u32 s64, 28
    s_cselect_b32 s48, 28, 0
    s_sub_u32 s64, s64, s48
    s_lshl_b32 s49, s64, 14
    s_add_u32 s49, s49, s59
    s_add_u32 m0, s61, 0
    s_add_u32 s3, s49, 0
    buffer_load_dwordx4 v10, s[28:31], s3 offen lds
    s_add_u32 m0, s61, 1024
    s_add_u32 s3, s49, 8192
    buffer_load_dwordx4 v10, s[28:31], s3 offen lds
    s_add_u32 s64, s63, 1
    s_cmp_ge_u32 s64, 28
    s_cselect_b32 s48, 28, 0
    s_sub_u32 s64, s64, s48
    s_lshl_b32 s49, s64, 14
    s_add_u32 s49, s49, s59
    s_add_u32 m0, s61, 2048
    s_add_u32 s3, s49, 0
    buffer_load_dwordx4 v10, s[28:31], s3 offen lds
    s_add_u32 m0, s61, 3072
    s_add_u32 s3, s49, 8192
    buffer_load_dwordx4 v10, s[28:31], s3 offen lds
    s_add_u32 s64, s63, 2
    s_cmp_ge_u32 s64, 28
    s_cselect_b32 s48, 28, 0
    s_sub_u32 s64, s64, s48
    s_lshl_b32 s49, s64, 14
    s_add_u32 s49, s49, s59
    s_add_u32 m0, s61, 4096
    s_add_u32 s3, s49, 0
    buffer_load_dwordx4 v10, s[28:31], s3 offen lds
    s_add_u32 m0, s61, 5120
    s_add_u32 s3, s49, 8192
    buffer_load_dwordx4 v10, s[28:31], s3 offen lds
    s_add_u32 s64, s63, 3
    s_cmp_ge_u32 s64, 28
    s_cselect_b32 s48, 28, 0
    s_sub_u32 s64, s64, s48
    s_lshl_b32 s49, s64, 14
    s_add_u32 s49, s49, s59
    s_add_u32 m0, s61, 6144
    s_add_u32 s3, s49, 0
    buffer_load_dwordx4 v10, s[28:31], s3 offen lds
    s_add_u32 m0, s61, 7168
    s_add_u32 s3, s49, 8192
    buffer_load_dwordx4 v10, s[28:31], s3 offen lds
    s_add_u32 s64, s63, 4
    s_cmp_ge_u32 s64, 28
    s_cselect_b32 s48, 28, 0
    s_sub_u32 s64, s64, s48
    s_lshl_b32 s49, s64, 14
    s_add_u32 s49, s49, s59
    s_add_u32 m0, s61, 8192
    s_add_u32 s3, s49, 0
    buffer_load_dwordx4 v10, s[28:31], s3 offen lds
    s_add_u32 m0, s61, 9216
    s_add_u32 s3, s49, 8192
    buffer_load_dwordx4 v10, s[28:31], s3 offen lds
    v_and_b32 v2, 15, v1
    v_lshrrev_b32 v2, 2, v2
    v_lshlrev_b32 v6, 7, v2
    v_lshrrev_b32 v2, 1, v2
    v_lshlrev_b32 v2, 6, v2
    v_add_u32 v6, v6, v2
    v_lshlrev_b32 v2, 1, v1
    v_and_b32 v2, 32, v2
    v_add_u32 v6, v6, v2
    v_and_b32 v2, 3, v1
    v_lshlrev_b32 v2, 3, v2
    v_add_u32 v6, v6, v2
    v_lshrrev_b32 v2, 5, v1
    v_mul_u32_u24 v2, 512, v2
    v_add_u32 v6, v6, v2
    v_add_u32 v6, s61, v6
    v_and_b32 v2, 15, v1
    v_lshrrev_b32 v2, 2, v2
    v_lshlrev_b32 v7, 7, v2
    v_lshrrev_b32 v2, 1, v2
    v_xor_b32 v2, 1, v2
    v_lshlrev_b32 v2, 6, v2
    v_add_u32 v7, v7, v2
    v_lshlrev_b32 v2, 1, v1
    v_and_b32 v2, 32, v2
    v_add_u32 v7, v7, v2
    v_and_b32 v2, 3, v1
    v_lshlrev_b32 v2, 3, v2
    v_add_u32 v7, v7, v2
    v_lshrrev_b32 v2, 5, v1
    v_mul_u32_u24 v2, 512, v2
    v_add_u32 v7, v7, v2
    v_add_u32 v7, s61, v7
    v_mov_b32 v2, 155712
    s_mov_b32 s58, 1600000
gated_mix__mha_block__glu_gated_reglu__prompt_kernel_d_spinx:
    ds_read_b32 v3, v2 offset:0
    s_waitcnt lgkmcnt(0)
    v_readfirstlane_b32 s62, v3
    s_cmp_ge_u32 s62, 4
    s_cbranch_scc1 gated_mix__mha_block__glu_gated_reglu__prompt_kernel_d_spinx_ok
    s_sub_u32 s58, s58, 1
    s_cmp_eq_u32 s58, 0
    s_cbranch_scc1 gated_mix__mha_block__glu_gated_reglu__prompt_kernel_d_spinx_ok
    s_sleep 1
    s_branch gated_mix__mha_block__glu_gated_reglu__prompt_kernel_d_spinx
gated_mix__mha_block__glu_gated_reglu__prompt_kernel_d_spinx_ok:
    s_lshl_b32 s57, s54, 17
    s_lshl_b32 s48, s53, 7
    s_add_u32 s57, s57, s48
    s_lshl_b32 s62, s54, 14
    s_mul_i32 s48, s54, 7
    v_add_u32 v2, s48, v1
    s_add_u32 s48, s55, 28
    v_mov_b32 v3, s48
    v_cmp_eq_u32 vcc, 7, v1
    s_nop 1
    v_cndmask_b32 v2, v2, v3, vcc
    v_lshlrev_b32 v2, 6, v2
    s_lshl_b32 s48, s52, 11
    s_add_u32 s48, s48, 8519680
    s_mov_b32 exec_lo, 0xff
    s_mov_b32 exec_hi, 0x0
    s_mov_b32 s58, 200000
gated_mix__mha_block__glu_gated_reglu__prompt_kernel_d_pollh:
    buffer_load_dword v3, v2, s[40:43], s48 offen sc1
    s_waitcnt vmcnt(0)
    v_cmp_ne_u32 vcc, s7, v3
    s_cbranch_vccz gated_mix__mha_block__glu_gated_reglu__prompt_kernel_d_pollh_ok
    s_sub_u32 s58, s58, 1
    s_cmp_eq_u32 s58, 0
    s_cbranch_scc1 gated_mix__mha_block__glu_gated_reglu__prompt_kernel_d_pollh_ok
    s_sleep 1
    s_branch gated_mix__mha_block__glu_gated_reglu__prompt_kernel_d_pollh
gated_mix__mha_block__glu_gated_reglu__prompt_kernel_d_pollh_ok:
    s_mov_b64 exec, -1
    s_lshl_b32 s48, s52, 8
    s_lshl_b32 s49, s55, 7
    s_add_u32 s48, s48, s49
    s_add_u32 s48, s48, 8388608
    v_and_b32 v2, 31, v1
    v_lshlrev_b32 v2, 2, v2
    buffer_load_dword v9, v2, s[40:43], s48 offen
    s_add_u32 s64, s63, 0
    s_cmp_ge_u32 s64, 28
    s_cselect_b32 s48, 28, 0
    s_sub_u32 s64, s64, s48
    s_lshl_b32 s50, s64, 10
    s_add_u32 s50, s50, s60
    s_add_u32 s3, s50, 0
    buffer_load_dwordx4 v[76:79], v8, s[40:43], s3 offen
    s_add_u32 s3, s50, 114688
    buffer_load_dwordx4 v[80:83], v8, s[40:43], s3 offen
    s_add_u32 s64, s63, 1
    s_cmp_ge_u32 s64, 28
    s_cselect_b32 s48, 28, 0
    s_sub_u32 s64, s64, s48
    s_lshl_b32 s50, s64, 10
    s_add_u32 s50, s50, s60
    s_add_u32 s3, s50, 0
    buffer_load_dwordx4 v[84:87], v8, s[40:43], s3 offen
    s_add_u32 s3, s50, 114688
    buffer_load_dwordx4 v[88:91], v8, s[40:43], s3 offen
    s_add_u32 s64, s63, 2
    s_cmp_ge_u32 s64, 28
    s_cselect_b32 s48, 28, 0
    s_sub_u32 s64, s64, s48
    s_lshl_b32 s50, s64, 10
    s_add_u32 s50, s50, s60
    s_add_u32 s3, s50, 0
    buffer_load_dwordx4 v[92:95], v8, s[40:43], s3 offen
    s_add_u32 s3, s50, 114688
    buffer_load_dwordx4 v[96:99], v8, s[40:43], s3 offen
    s_add_u32 s64, s63, 3
    s_cmp_ge_u32 s64, 28
    s_cselect_b32 s48, 28, 0
    s_sub_u32 s64, s64, s48
    s_lshl_b32 s50, s64, 10
    s_add_u32 s50, s50, s60
    s_add_u32 s3, s50, 0
    buffer_load_dwordx4 v[100:103], v8, s[40:43], s3 offen
    s_add_u32 s3, s50, 114688
    buffer_load_dwordx4 v[104:107], v8, s[40:43], s3 offen
    s_add_u32 s64, s63, 4
    s_cmp_ge_u32 s64, 28
    s_cselect_b32 s48, 28, 0
    s_sub_u32 s64, s64, s48
    s_lshl_b32 s50, s64, 10
    s_add_u32 s50, s50, s60
    s_add_u32 s3, s50, 0
    buffer_load_dwordx4 v[108:111], v8, s[40:43], s3 offen
    s_add_u32 s3, s50, 114688
    buffer_load_dwordx4 v[112:115], v8, s[40:43], s3 offen
    s_setprio 0
    ds_read_b64_tr_b16 v[124:125], v6 offset:0
    ds_read_b64_tr_b16 v[126:127], v6 offset:1024
    ds_read_b64_tr_b16 v[128:129], v7 offset:0
    ds_read_b64_tr_b16 v[130:131], v7 offset:1024
    s_waitcnt vmcnt(8)
    ds_read_b64_tr_b16 v[132:133], v6 offset:2048
    ds_read_b64_tr_b16 v[134:135], v6 offset:3072
    ds_read_b64_tr_b16 v[136:137], v7 offset:2048
    ds_read_b64_tr_b16 v[138:139], v7 offset:3072
    s_waitcnt lgkmcnt(4)
    v_mfma_f32_32x32x16_bf16 v[12:27], v[124:127], v[76:79], 0
    s_add_u32 s64, s63, 5
    s_cmp_ge_u32 s64, 28
    s_cselect_b32 s48, 28, 0
    s_sub_u32 s64, s64, s48
    s_lshl_b32 s49, s64, 14
    s_add_u32 s49, s49, s59
    s_add_u32 m0, s61, 10240
    s_add_u32 s3, s49, 0
    buffer_load_dwordx4 v10, s[28:31], s3 offen lds
    s_setprio 1
    v_mfma_f32_32x32x16_bf16 v[44:59], v[128:131], v[76:79], 0
    s_setprio 0
    s_add_u32 m0, s61, 11264
    s_add_u32 s3, s49, 8192
    buffer_load_dwordx4 v10, s[28:31], s3 offen lds
    v_mfma_f32_32x32x16_bf16 v[28:43], v[124:127], v[80:83], 0
    s_setprio 1
    v_mfma_f32_32x32x16_bf16 v[60:75], v[128:131], v[80:83], 0
    s_setprio 0
    s_add_u32 s64, s63, 5
    s_cmp_ge_u32 s64, 28
    s_cselect_b32 s48, 28, 0
    s_sub_u32 s64, s64, s48
    s_lshl_b32 s50, s64, 10
    s_add_u32 s50, s50, s60
    s_add_u32 s3, s50, 0
    buffer_load_dwordx4 v[116:119], v8, s[40:43], s3 offen
    s_add_u32 s3, s50, 114688
    buffer_load_dwordx4 v[120:123], v8, s[40:43], s3 offen
    s_waitcnt vmcnt(10)
    ds_read_b64_tr_b16 v[124:125], v6 offset:4096
    ds_read_b64_tr_b16 v[126:127], v6 offset:5120
    ds_read_b64_tr_b16 v[128:129], v7 offset:4096
    ds_read_b64_tr_b16 v[130:131], v7 offset:5120
    s_waitcnt lgkmcnt(4)
    v_mfma_f32_32x32x16_bf16 v[12:27], v[132:135], v[84:87], v[12:27]
    s_add_u32 s64, s63, 6
    s_cmp_ge_u32 s64, 28
    s_cselect_b32 s48, 28, 0
    s_sub_u32 s64, s64, s48
    s_lshl_b32 s49, s64, 14
    s_add_u32 s49, s49, s59
    s_add_u32 m0, s61, 0
    s_add_u32 s3, s49, 0
    buffer_load_dwordx4 v10, s[28:31], s3 offen lds
    s_setprio 1
    v_mfma_f32_32x32x16_bf16 v[44:59], v[136:139], v[84:87], v[44:59]
    s_setprio 0
    s_add_u32 m0, s61, 1024
    s_add_u32 s3, s49, 8192
    buffer_load_dwordx4 v10, s[28:31], s3 offen lds
    v_mfma_f32_32x32x16_bf16 v[28:43], v[132:135], v[88:91], v[28:43]
    s_setprio 1
    v_mfma_f32_32x32x16_bf16 v[60:75], v[136:139], v[88:91], v[60:75]
    s_setprio 0
    s_add_u32 s64, s63, 6
    s_cmp_ge_u32 s64, 28
    s_cselect_b32 s48, 28, 0
    s_sub_u32 s64, s64, s48
    s_lshl_b32 s50, s64, 10
    s_add_u32 s50, s50, s60
    s_add_u32 s3, s50, 0
    buffer_load_dwordx4 v[76:79], v8, s[40:43], s3 offen
    s_add_u32 s3, s50, 114688
    buffer_load_dwordx4 v[80:83], v8, s[40:43], s3 offen
    s_waitcnt vmcnt(12)
    ds_read_b64_tr_b16 v[132:133], v6 offset:6144
    ds_read_b64_tr_b16 v[134:135], v6 offset:7168
    ds_read_b64_tr_b16 v[136:137], v7 offset:6144
    ds_read_b64_tr_b16 v[138:139], v7 offset:7168
    s_waitcnt lgkmcnt(4)
    v_mfma_f32_32x32x16_bf16 v[12:27], v[124:127], v[92:95], v[12:27]
    s_add_u32 s64, s63, 7
    s_cmp_ge_u32 s64, 28
    s_cselect_b32 s48, 28, 0
    s_sub_u32 s64, s64, s48
    s_lshl_b32 s49, s64, 14
    s_add_u32 s49, s49, s59
    s_add_u32 m0, s61, 2048
    s_add_u32 s3, s49, 0
    buffer_load_dwordx4 v10, s[28:31], s3 offen lds
    s_setprio 1
    v_mfma_f32_32x32x16_bf16 v[44:59], v[128:131], v[92:95], v[44:59]
    s_setprio 0
    s_add_u32 m0, s61, 3072
    s_add_u32 s3, s49, 8192
    buffer_load_dwordx4 v10, s[28:31], s3 offen lds
    v_mfma_f32_32x32x16_bf16 v[28:43], v[124:127], v[96:99], v[28:43]
    s_setprio 1
    v_mfma_f32_32x32x16_bf16 v[60:75], v[128:131], v[96:99], v[60:75]
    s_setprio 0
    s_add_u32 s64, s63, 7
    s_cmp_ge_u32 s64, 28
    s_cselect_b32 s48, 28, 0
    s_sub_u32 s64, s64, s48
    s_lshl_b32 s50, s64, 10
    s_add_u32 s50, s50, s60
    s_add_u32 s3, s50, 0
    buffer_load_dwordx4 v[84:87], v8, s[40:43], s3 offen
    s_add_u32 s3, s50, 114688
    buffer_load_dwordx4 v[88:91], v8, s[40:43], s3 offen
    s_waitcnt vmcnt(14)
    ds_read_b64_tr_b16 v[124:125], v6 offset:8192
    ds_read_b64_tr_b16 v[126:127], v6 offset:9216
    ds_read_b64_tr_b16 v[128:129], v7 offset:8192
    ds_read_b64_tr_b16 v[130:131], v7 offset:9216
    s_waitcnt lgkmcnt(4)
    v_mfma_f32_32x32x16_bf16 v[12:27], v[132:135], v[100:103], v[12:27]
    s_add_u32 s64, s63, 8
    s_cmp_ge_u32 s64, 28
    s_cselect_b32 s48, 28, 0
    s_sub_u32 s64, s64, s48
    s_lshl_b32 s49, s64, 14
    s_add_u32 s49, s49, s59
    s_add_u32 m0, s61, 4096
    s_add_u32 s3, s49, 0
    buffer_load_dwordx4 v10, s[28:31], s3 offen lds
    s_setprio 1
    v_mfma_f32_32x32x16_bf16 v[44:59], v[136:139], v[100:103], v[44:59]
    s_setprio 0
    s_add_u32 m0, s61, 5120
    s_add_u32 s3, s49, 8192
    buffer_load_dwordx4 v10, s[28:31], s3 offen lds
    v_mfma_f32_32x32x16_bf16 v[28:43], v[132:135], v[104:107], v[28:43]
    s_setprio 1
    v_mfma_f32_32x32x16_bf16 v[60:75], v[136:139], v[104:107], v[60:75]
    s_setprio 0
    s_add_u32 s64, s63, 8
    s_cmp_ge_u32 s64, 28
    s_cselect_b32 s48, 28, 0
    s_sub_u32 s64, s64, s48
    s_lshl_b32 s50, s64, 10
    s_add_u32 s50, s50, s60
    s_add_u32 s3, s50, 0
    buffer_load_dwordx4 v[92:95], v8, s[40:43], s3 offen
    s_add_u32 s3, s50, 114688
    buffer_load_dwordx4 v[96:99], v8, s[40:43], s3 offen
    s_waitcnt vmcnt(14)
    ds_read_b64_tr_b16 v[132:133], v6 offset:10240
    ds_read_b64_tr_b16 v[134:135], v6 offset:11264
    ds_read_b64_tr_b16 v[136:137], v7 offset:10240
    ds_read_b64_tr_b16 v[138:139], v7 offset:11264
    s_waitcnt lgkmcnt(4)
    v_mfma_f32_32x32x16_bf16 v[12:27], v[124:127], v[108:111], v[12:27]
    s_add_u32 s64, s63, 9
    s_cmp_ge_u32 s64, 28
    s_cselect_b32 s48, 28, 0
    s_sub_u32 s64, s64, s48
    s_lshl_b32 s49, s64, 14
    s_add_u32 s49, s49, s59
    s_add_u32 m0, s61, 6144
    s_add_u32 s3, s49, 0
    buffer_load_dwordx4 v10, s[28:31], s3 offen lds
    s_setprio 1
    v_mfma_f32_32x32x16_bf16 v[44:59], v[128:131], v[108:111], v[44:59]
    s_setprio 0
    s_add_u32 m0, s61, 7168
    s_add_u32 s3, s49, 8192
    buffer_load_dwordx4 v10, s[28:31], s3 offen lds
    v_mfma_f32_32x32x16_bf16 v[28:43], v[124:127], v[112:115], v[28:43]
    s_setprio 1
    v_mfma_f32_32x32x16_bf16 v[60:75], v[128:131], v[112:115], v[60:75]
    s_setprio 0
    s_add_u32 s64, s63, 9
    s_cmp_ge_u32 s64, 28
    s_cselect_b32 s48, 28, 0
    s_sub_u32 s64, s64, s48
    s_lshl_b32 s50, s64, 10
    s_add_u32 s50, s50, s60
    s_add_u32 s3, s50, 0
    buffer_load_dwordx4 v[100:103], v8, s[40:43], s3 offen
    s_add_u32 s3, s50, 114688
    buffer_load_dwordx4 v[104:107], v8, s[40:43], s3 offen
    s_waitcnt vmcnt(14)
    ds_read_b64_tr_b16 v[124:125], v6 offset:0
    ds_read_b64_tr_b16 v[126:127], v6 offset:1024
    ds_read_b64_tr_b16 v[128:129], v7 offset:0
    ds_read_b64_tr_b16 v[130:131], v7 offset:1024
    s_waitcnt lgkmcnt(4)
    v_mfma_f32_32x32x16_bf16 v[12:27], v[132:135], v[116:119], v[12:27]
    s_add_u32 s64, s63, 10
    s_cmp_ge_u32 s64, 28
    s_cselect_b32 s48, 28, 0
    s_sub_u32 s64, s64, s48
    s_lshl_b32 s49, s64, 14
    s_add_u32 s49, s49, s59
    s_add_u32 m0, s61, 8192
    s_add_u32 s3, s49, 0
    buffer_load_dwordx4 v10, s[28:31], s3 offen lds
    s_setprio 1
    v_mfma_f32_32x32x16_bf16 v[44:59], v[136:139], v[116:119], v[44:59]
    s_setprio 0
    s_add_u32 m0, s61, 9216
    s_add_u32 s3, s49, 8192
    buffer_load_dwordx4 v10, s[28:31], s3 offen lds
    v_mfma_f32_32x32x16_bf16 v[28:43], v[132:135], v[120:123], v[28:43]
    s_setprio 1
    v_mfma_f32_32x32x16_bf16 v[60:75], v[136:139], v[120:123], v[60:75]
    s_setprio 0
    s_add_u32 s64, s63, 10
    s_cmp_ge_u32 s64, 28
    s_cselect_b32 s48, 28, 0
    s_sub_u32 s64, s64, s48
    s_lshl_b32 s50, s64, 10
    s_add_u32 s50, s50, s60
    s_add_u32 s3, s50, 0
    buffer_load_dwordx4 v[108:111], v8, s[40:43], s3 offen
    s_add_u32 s3, s50, 114688
    buffer_load_dwordx4 v[112:115], v8, s[40:43], s3 offen
    s_waitcnt vmcnt(14)
    ds_read_b64_tr_b16 v[132:133], v6 offset:2048
    ds_read_b64_tr_b16 v[134:135], v6 offset:3072
    ds_read_b64_tr_b16 v[136:137], v7 offset:2048
    ds_read_b64_tr_b16 v[138:139], v7 offset:3072
    s_waitcnt lgkmcnt(4)
    v_mfma_f32_32x32x16_bf16 v[12:27], v[124:127], v[76:79], v[12:27]
    s_add_u32 s64, s63, 11
    s_cmp_ge_u32 s64, 28
    s_cselect_b32 s48, 28, 0
    s_sub_u32 s64, s64, s48
    s_lshl_b32 s49, s64, 14
    s_add_u32 s49, s49, s59
    s_add_u32 m0, s61, 10240
    s_add_u32 s3, s49, 0
    buffer_load_dwordx4 v10, s[28:31], s3 offen lds
    s_setprio 1
    v_mfma_f32_32x32x16_bf16 v[44:59], v[128:131], v[76:79], v[44:59]
    s_setprio 0
    s_add_u32 m0, s61, 11264
    s_add_u32 s3, s49, 8192
    buffer_load_dwordx4 v10, s[28:31], s3 offen lds
    v_mfma_f32_32x32x16_bf16 v[28:43], v[124:127], v[80:83], v[28:43]
    s_setprio 1
    v_mfma_f32_32x32x16_bf16 v[60:75], v[128:131], v[80:83], v[60:75]
    s_setprio 0
    s_add_u32 s64, s63, 11
    s_cmp_ge_u32 s64, 28
    s_cselect_b32 s48, 28, 0
    s_sub_u32 s64, s64, s48
    s_lshl_b32 s50, s64, 10
    s_add_u32 s50, s50, s60
    s_add_u32 s3, s50, 0
    buffer_load_dwordx4 v[116:119], v8, s[40:43], s3 offen
    s_add_u32 s3, s50, 114688
    buffer_load_dwordx4 v[120:123], v8, s[40:43], s3 offen
    s_waitcnt vmcnt(14)
    ds_read_b64_tr_b16 v[124:125], v6 offset:4096
    ds_read_b64_tr_b16 v[126:127], v6 offset:5120
    ds_read_b64_tr_b16 v[128:129], v7 offset:4096
    ds_read_b64_tr_b16 v[130:131], v7 offset:5120
    s_waitcnt lgkmcnt(4)
    v_mfma_f32_32x32x16_bf16 v[12:27], v[132:135], v[84:87], v[12:27]
    s_add_u32 s64, s63, 12
    s_cmp_ge_u32 s64, 28
    s_cselect_b32 s48, 28, 0
    s_sub_u32 s64, s64, s48
    s_lshl_b32 s49, s64, 14
    s_add_u32 s49, s49, s59
    s_add_u32 m0, s61, 0
    s_add_u32 s3, s49, 0
    buffer_load_dwordx4 v10, s[28:31], s3 offen lds
    s_setprio 1
    v_mfma_f32_32x32x16_bf16 v[44:59], v[136:139], v[84:87], v[44:59]
    s_setprio 0
    s_add_u32 m0, s61, 1024
    s_add_u32 s3, s49, 8192
    buffer_load_dwordx4 v10, s[28:31], s3 offen lds
    v_mfma_f32_32x32x16_bf16 v[28:43], v[132:135], v[88:91], v[28:43]
    s_setprio 1
    v_mfma_f32_32x32x16_bf16 v[60:75], v[136:139], v[88:91], v[60:75]
    s_setprio 0
    s_add_u32 s64, s63, 12
    s_cmp_ge_u32 s64, 28
    s_cselect_b32 s48, 28, 0
    s_sub_u32 s64, s64, s48
    s_lshl_b32 s50, s64, 10
    s_add_u32 s50, s50, s60
    s_add_u32 s3, s50, 0
    buffer_load_dwordx4 v[76:79], v8, s[40:43], s3 offen
    s_add_u32 s3, s50, 114688
    buffer_load_dwordx4 v[80:83], v8, s[40:43], s3 offen
    s_waitcnt vmcnt(14)
    ds_read_b64_tr_b16 v[132:133], v6 offset:6144
    ds_read_b64_tr_b16 v[134:135], v6 offset:7168
    ds_read_b64_tr_b16 v[136:137], v7 offset:6144
    ds_read_b64_tr_b16 v[138:139], v7 offset:7168
    s_waitcnt lgkmcnt(4)
    v_mfma_f32_32x32x16_bf16 v[12:27], v[124:127], v[92:95], v[12:27]
    s_add_u32 s64, s63, 13
    s_cmp_ge_u32 s64, 28
    s_cselect_b32 s48, 28, 0
    s_sub_u32 s64, s64, s48
    s_lshl_b32 s49, s64, 14
    s_add_u32 s49, s49, s59
    s_add_u32 m0, s61, 2048
    s_add_u32 s3, s49, 0
    buffer_load_dwordx4 v10, s[28:31], s3 offen lds
    s_setprio 1
    v_mfma_f32_32x32x16_bf16 v[44:59], v[128:131], v[92:95], v[44:59]
    s_setprio 0
    s_add_u32 m0, s61, 3072
    s_add_u32 s3, s49, 8192
    buffer_load_dwordx4 v10, s[28:31], s3 offen lds
    v_mfma_f32_32x32x16_bf16 v[28:43], v[124:127], v[96:99], v[28:43]
    s_setprio 1
    v_mfma_f32_32x32x16_bf16 v[60:75], v[128:131], v[96:99], v[60:75]
    s_setprio 0
    s_add_u32 s64, s63, 13
    s_cmp_ge_u32 s64, 28
    s_cselect_b32 s48, 28, 0
    s_sub_u32 s64, s64, s48
    s_lshl_b32 s50, s64, 10
    s_add_u32 s50, s50, s60
    s_add_u32 s3, s50, 0
    buffer_load_dwordx4 v[84:87], v8, s[40:43], s3 offen
    s_add_u32 s3, s50, 114688
    buffer_load_dwordx4 v[88:91], v8, s[40:43], s3 offen
    s_waitcnt vmcnt(14)
    ds_read_b64_tr_b16 v[124:125], v6 offset:8192
    ds_read_b64_tr_b16 v[126:127], v6 offset:9216
    ds_read_b64_tr_b16 v[128:129], v7 offset:8192
    ds_read_b64_tr_b16 v[130:131], v7 offset:9216
    s_waitcnt lgkmcnt(4)
    v_mfma_f32_32x32x16_bf16 v[12:27], v[132:135], v[100:103], v[12:27]
    s_add_u32 s64, s63, 14
    s_cmp_ge_u32 s64, 28
    s_cselect_b32 s48, 28, 0
    s_sub_u32 s64, s64, s48
    s_lshl_b32 s49, s64, 14
    s_add_u32 s49, s49, s59
    s_add_u32 m0, s61, 4096
    s_add_u32 s3, s49, 0
    buffer_load_dwordx4 v10, s[28:31], s3 offen lds
    s_setprio 1
    v_mfma_f32_32x32x16_bf16 v[44:59], v[136:139], v[100:103], v[44:59]
    s_setprio 0
    s_add_u32 m0, s61, 5120
    s_add_u32 s3, s49, 8192
    buffer_load_dwordx4 v10, s[28:31], s3 offen lds
    v_mfma_f32_32x32x16_bf16 v[28:43], v[132:135], v[104:107], v[28:43]
    s_setprio 1
    v_mfma_f32_32x32x16_bf16 v[60:75], v[136:139], v[104:107], v[60:75]
    s_setprio 0
    s_add_u32 s64, s63, 14
    s_cmp_ge_u32 s64, 28
    s_cselect_b32 s48, 28, 0
    s_sub_u32 s64, s64, s48
    s_lshl_b32 s50, s64, 10
    s_add_u32 s50, s50, s60
    s_add_u32 s3, s50, 0
    buffer_load_dwordx4 v[92:95], v8, s[40:43], s3 offen
    s_add_u32 s3, s50, 114688
    buffer_load_dwordx4 v[96:99], v8, s[40:43], s3 offen
    s_waitcnt vmcnt(14)
    ds_read_b64_tr_b16 v[132:133], v6 offset:10240
    ds_read_b64_tr_b16 v[134:135], v6 offset:11264
    ds_read_b64_tr_b16 v[136:137], v7 offset:10240
    ds_read_b64_tr_b16 v[138:139], v7 offset:11264
    s_waitcnt lgkmcnt(4)
    v_mfma_f32_32x32x16_bf16 v[12:27], v[124:127], v[108:111], v[12:27]
    s_add_u32 s64, s63, 15
    s_cmp_ge_u32 s64, 28
    s_cselect_b32 s48, 28, 0
    s_sub_u32 s64, s64, s48
    s_lshl_b32 s49, s64, 14
    s_add_u32 s49, s49, s59
    s_add_u32 m0, s61, 6144
    s_add_u32 s3, s49, 0
    buffer_load_dwordx4 v10, s[28:31], s3 offen lds
    s_setprio 1
    v_mfma_f32_32x32x16_bf16 v[44:59], v[128:131], v[108:111], v[44:59]
    s_setprio 0
    s_add_u32 m0, s61, 7168
    s_add_u32 s3, s49, 8192
    buffer_load_dwordx4 v10, s[28:31], s3 offen lds
    v_mfma_f32_32x32x16_bf16 v[28:43], v[124:127], v[112:115], v[28:43]
    s_setprio 1
    v_mfma_f32_32x32x16_bf16 v[60:75], v[128:131], v[112:115], v[60:75]
    s_setprio 0
    s_add_u32 s64, s63, 15
    s_cmp_ge_u32 s64, 28
    s_cselect_b32 s48, 28, 0
    s_sub_u32 s64, s64, s48
    s_lshl_b32 s50, s64, 10
    s_add_u32 s50, s50, s60
    s_add_u32 s3, s50, 0
    buffer_load_dwordx4 v[100:103], v8, s[40:43], s3 offen
    s_add_u32 s3, s50, 114688
    buffer_load_dwordx4 v[104:107], v8, s[40:43], s3 offen
    s_waitcnt vmcnt(14)
    ds_read_b64_tr_b16 v[124:125], v6 offset:0
    ds_read_b64_tr_b16 v[126:127], v6 offset:1024
    ds_read_b64_tr_b16 v[128:129], v7 offset:0
    ds_read_b64_tr_b16 v[130:131], v7 offset:1024
    s_waitcnt lgkmcnt(4)
    v_mfma_f32_32x32x16_bf16 v[12:27], v[132:135], v[116:119], v[12:27]
    s_add_u32 s64, s63, 16
    s_cmp_ge_u32 s64, 28
    s_cselect_b32 s48, 28, 0
    s_sub_u32 s64, s64, s48
    s_lshl_b32 s49, s64, 14
    s_add_u32 s49, s49, s59
    s_add_u32 m0, s61, 8192
    s_add_u32 s3, s49, 0
    buffer_load_dwordx4 v10, s[28:31], s3 offen lds
    s_setprio 1
    v_mfma_f32_32x32x16_bf16 v[44:59], v[136:139], v[116:119], v[44:59]
    s_setprio 0
    s_add_u32 m0, s61, 9216
    s_add_u32 s3, s49, 8192
    buffer_load_dwordx4 v10, s[28:31], s3 offen lds
    v_mfma_f32_32x32x16_bf16 v[28:43], v[132:135], v[120:123], v[28:43]
    s_setprio 1
    v_mfma_f32_32x32x16_bf16 v[60:75], v[136:139], v[120:123], v[60:75]
    s_setprio 0
    s_add_u32 s64, s63, 16
    s_cmp_ge_u32 s64, 28
    s_cselect_b32 s48, 28, 0
    s_sub_u32 s64, s64, s48
    s_lshl_b32 s50, s64, 10
    s_add_u32 s50, s50, s60
    s_add_u32 s3, s50, 0
    buffer_load_dwordx4 v[108:111], v8, s[40:43], s3 offen
    s_add_u32 s3, s50, 114688
    buffer_load_dwordx4 v[112:115], v8, s[40:43], s3 offen
    s_waitcnt vmcnt(14)
    ds_read_b64_tr_b16 v[132:133], v6 offset:2048
    ds_read_b64_tr_b16 v[134:135], v6 offset:3072
    ds_read_b64_tr_b16 v[136:137], v7 offset:2048
    ds_read_b64_tr_b16 v[138:139], v7 offset:3072
    s_waitcnt lgkmcnt(4)
    v_mfma_f32_32x32x16_bf16 v[12:27], v[124:127], v[76:79], v[12:27]
    s_add_u32 s64, s63, 17
    s_cmp_ge_u32 s64, 28
    s_cselect_b32 s48, 28, 0
    s_sub_u32 s64, s64, s48
    s_lshl_b32 s49, s64, 14
    s_add_u32 s49, s49, s59
    s_add_u32 m0, s61, 10240
    s_add_u32 s3, s49, 0
    buffer_load_dwordx4 v10, s[28:31], s3 offen lds
    s_setprio 1
    v_mfma_f32_32x32x16_bf16 v[44:59], v[128:131], v[76:79], v[44:59]
    s_setprio 0
    s_add_u32 m0, s61, 11264
    s_add_u32 s3, s49, 8192
    buffer_load_dwordx4 v10, s[28:31], s3 offen lds
    v_mfma_f32_32x32x16_bf16 v[28:43], v[124:127], v[80:83], v[28:43]
    s_setprio 1
    v_mfma_f32_32x32x16_bf16 v[60:75], v[128:131], v[80:83], v[60:75]
    s_setprio 0
    s_add_u32 s64, s63, 17
    s_cmp_ge_u32 s64, 28
    s_cselect_b32 s48, 28, 0
    s_sub_u32 s64, s64, s48
    s_lshl_b32 s50, s64, 10
    s_add_u32 s50, s50, s60
    s_add_u32 s3, s50, 0
    buffer_load_dwordx4 v[116:119], v8, s[40:43], s3 offen
    s_add_u32 s3, s50, 114688
    buffer_load_dwordx4 v[120:123], v8, s[40:43], s3 offen
    s_waitcnt vmcnt(14)
    ds_read_b64_tr_b16 v[124:125], v6 offset:4096
    ds_read_b64_tr_b16 v[126:127], v6 offset:5120
    ds_read_b64_tr_b16 v[128:129], v7 offset:4096
    ds_read_b64_tr_b16 v[130:131], v7 offset:5120
    s_waitcnt lgkmcnt(4)
    v_mfma_f32_32x32x16_bf16 v[12:27], v[132:135], v[84:87], v[12:27]
    s_add_u32 s64, s63, 18
    s_cmp_ge_u32 s64, 28
    s_cselect_b32 s48, 28, 0
    s_sub_u32 s64, s64, s48
    s_lshl_b32 s49, s64, 14
    s_add_u32 s49, s49, s59
    s_add_u32 m0, s61, 0
    s_add_u32 s3, s49, 0
    buffer_load_dwordx4 v10, s[28:31], s3 offen lds
    s_setprio 1
    v_mfma_f32_32x32x16_bf16 v[44:59], v[136:139], v[84:87], v[44:59]
    s_setprio 0
    s_add_u32 m0, s61, 1024
    s_add_u32 s3, s49, 8192
    buffer_load_dwordx4 v10, s[28:31], s3 offen lds
    v_mfma_f32_32x32x16_bf16 v[28:43], v[132:135], v[88:91], v[28:43]
    s_setprio 1
    v_mfma_f32_32x32x16_bf16 v[60:75], v[136:139], v[88:91], v[60:75]
    s_setprio 0
    s_add_u32 s64, s63, 18
    s_cmp_ge_u32 s64, 28
    s_cselect_b32 s48, 28, 0
    s_sub_u32 s64, s64, s48
    s_lshl_b32 s50, s64, 10
    s_add_u32 s50, s50, s60
    s_add_u32 s3, s50, 0
    buffer_load_dwordx4 v[76:79], v8, s[40:43], s3 offen
    s_add_u32 s3, s50, 114688
    buffer_load_dwordx4 v[80:83], v8, s[40:43], s3 offen
    s_waitcnt vmcnt(14)
    ds_read_b64_tr_b16 v[132:133], v6 offset:6144
    ds_read_b64_tr_b16 v[134:135], v6 offset:7168
    ds_read_b64_tr_b16 v[136:137], v7 offset:6144
    ds_read_b64_tr_b16 v[138:139], v7 offset:7168
    s_waitcnt lgkmcnt(4)
    v_mfma_f32_32x32x16_bf16 v[12:27], v[124:127], v[92:95], v[12:27]
    s_add_u32 s64, s63, 19
    s_cmp_ge_u32 s64, 28
    s_cselect_b32 s48, 28, 0
    s_sub_u32 s64, s64, s48
    s_lshl_b32 s49, s64, 14
    s_add_u32 s49, s49, s59
    s_add_u32 m0, s61, 2048
    s_add_u32 s3, s49, 0
    buffer_load_dwordx4 v10, s[28:31], s3 offen lds
    s_setprio 1
    v_mfma_f32_32x32x16_bf16 v[44:59], v[128:131], v[92:95], v[44:59]
    s_setprio 0
    s_add_u32 m0, s61, 3072
    s_add_u32 s3, s49, 8192
    buffer_load_dwordx4 v10, s[28:31], s3 offen lds
    v_mfma_f32_32x32x16_bf16 v[28:43], v[124:127], v[96:99], v[28:43]
    s_setprio 1
    v_mfma_f32_32x32x16_bf16 v[60:75], v[128:131], v[96:99], v[60:75]
    s_setprio 0
    s_add_u32 s64, s63, 19
    s_cmp_ge_u32 s64, 28
    s_cselect_b32 s48, 28, 0
    s_sub_u32 s64, s64, s48
    s_lshl_b32 s50, s64, 10
    s_add_u32 s50, s50, s60
    s_add_u32 s3, s50, 0
    buffer_load_dwordx4 v[84:87], v8, s[40:43], s3 offen
    s_add_u32 s3, s50, 114688
    buffer_load_dwordx4 v[88:91], v8, s[40:43], s3 offen
    s_waitcnt vmcnt(14)
    ds_read_b64_tr_b16 v[124:125], v6 offset:8192
    ds_read_b64_tr_b16 v[126:127], v6 offset:9216
    ds_read_b64_tr_b16 v[128:129], v7 offset:8192
    ds_read_b64_tr_b16 v[130:131], v7 offset:9216
    s_waitcnt lgkmcnt(4)
    v_mfma_f32_32x32x16_bf16 v[12:27], v[132:135], v[100:103], v[12:27]
    s_add_u32 s64, s63, 20
    s_cmp_ge_u32 s64, 28
    s_cselect_b32 s48, 28, 0
    s_sub_u32 s64, s64, s48
    s_lshl_b32 s49, s64, 14
    s_add_u32 s49, s49, s59
    s_add_u32 m0, s61, 4096
    s_add_u32 s3, s49, 0
    buffer_load_dwordx4 v10, s[28:31], s3 offen lds
    s_setprio 1
    v_mfma_f32_32x32x16_bf16 v[44:59], v[136:139], v[100:103], v[44:59]
    s_setprio 0
    s_add_u32 m0, s61, 5120
    s_add_u32 s3, s49, 8192
    buffer_load_dwordx4 v10, s[28:31], s3 offen lds
    v_mfma_f32_32x32x16_bf16 v[28:43], v[132:135], v[104:107], v[28:43]
    s_setprio 1
    v_mfma_f32_32x32x16_bf16 v[60:75], v[136:139], v[104:107], v[60:75]
    s_setprio 0
    s_add_u32 s64, s63, 20
    s_cmp_ge_u32 s64, 28
    s_cselect_b32 s48, 28, 0
    s_sub_u32 s64, s64, s48
    s_lshl_b32 s50, s64, 10
    s_add_u32 s50, s50, s60
    s_add_u32 s3, s50, 0
    buffer_load_dwordx4 v[92:95], v8, s[40:43], s3 offen
    s_add_u32 s3, s50, 114688
    buffer_load_dwordx4 v[96:99], v8, s[40:43], s3 offen
    s_waitcnt vmcnt(14)
    ds_read_b64_tr_b16 v[132:133], v6 offset:10240
    ds_read_b64_tr_b16 v[134:135], v6 offset:11264
    ds_read_b64_tr_b16 v[136:137], v7 offset:10240
    ds_read_b64_tr_b16 v[138:139], v7 offset:11264
    s_waitcnt lgkmcnt(4)
    v_mfma_f32_32x32x16_bf16 v[12:27], v[124:127], v[108:111], v[12:27]
    s_add_u32 s64, s63, 21
    s_cmp_ge_u32 s64, 28
    s_cselect_b32 s48, 28, 0
    s_sub_u32 s64, s64, s48
    s_lshl_b32 s49, s64, 14
    s_add_u32 s49, s49, s59
    s_add_u32 m0, s61, 6144
    s_add_u32 s3, s49, 0
    buffer_load_dwordx4 v10, s[28:31], s3 offen lds
    s_setprio 1
    v_mfma_f32_32x32x16_bf16 v[44:59], v[128:131], v[108:111], v[44:59]
    s_setprio 0
    s_add_u32 m0, s61, 7168
    s_add_u32 s3, s49, 8192
    buffer_load_dwordx4 v10, s[28:31], s3 offen lds
    v_mfma_f32_32x32x16_bf16 v[28:43], v[124:127], v[112:115], v[28:43]
    s_setprio 1
    v_mfma_f32_32x32x16_bf16 v[60:75], v[128:131], v[112:115], v[60:75]
    s_setprio 0
    s_add_u32 s64, s63, 21
    s_cmp_ge_u32 s64, 28
    s_cselect_b32 s48, 28, 0
    s_sub_u32 s64, s64, s48
    s_lshl_b32 s50, s64, 10
    s_add_u32 s50, s50, s60
    s_add_u32 s3, s50, 0
    buffer_load_dwordx4 v[100:103], v8, s[40:43], s3 offen
    s_add_u32 s3, s50, 114688
    buffer_load_dwordx4 v[104:107], v8, s[40:43], s3 offen
    s_waitcnt vmcnt(14)
    ds_read_b64_tr_b16 v[124:125], v6 offset:0
    ds_read_b64_tr_b16 v[126:127], v6 offset:1024
    ds_read_b64_tr_b16 v[128:129], v7 offset:0
    ds_read_b64_tr_b16 v[130:131], v7 offset:1024
    s_waitcnt lgkmcnt(4)
    v_mfma_f32_32x32x16_bf16 v[12:27], v[132:135], v[116:119], v[12:27]
    s_add_u32 s64, s63, 22
    s_cmp_ge_u32 s64, 28
    s_cselect_b32 s48, 28, 0
    s_sub_u32 s64, s64, s48
    s_lshl_b32 s49, s64, 14
    s_add_u32 s49, s49, s59
    s_add_u32 m0, s61, 8192
    s_add_u32 s3, s49, 0
    buffer_load_dwordx4 v10, s[28:31], s3 offen lds
    s_setprio 1
    v_mfma_f32_32x32x16_bf16 v[44:59], v[136:139], v[116:119], v[44:59]
    s_setprio 0
    s_add_u32 m0, s61, 9216
    s_add_u32 s3, s49, 8192
    buffer_load_dwordx4 v10, s[28:31], s3 offen lds
    v_mfma_f32_32x32x16_bf16 v[28:43], v[132:135], v[120:123], v[28:43]
    s_setprio 1
    v_mfma_f32_32x32x16_bf16 v[60:75], v[136:139], v[120:123], v[60:75]
    s_setprio 0
    s_add_u32 s64, s63, 22
    s_cmp_ge_u32 s64, 28
    s_cselect_b32 s48, 28, 0
    s_sub_u32 s64, s64, s48
    s_lshl_b32 s50, s64, 10
    s_add_u32 s50, s50, s60
    s_add_u32 s3, s50, 0
    buffer_load_dwordx4 v[108:111], v8, s[40:43], s3 offen
    s_add_u32 s3, s50, 114688
    buffer_load_dwordx4 v[112:115], v8, s[40:43], s3 offen
    s_waitcnt vmcnt(14)
    ds_read_b64_tr_b16 v[132:133], v6 offset:2048
    ds_read_b64_tr_b16 v[134:135], v6 offset:3072
    ds_read_b64_tr_b16 v[136:137], v7 offset:2048
    ds_read_b64_tr_b16 v[138:139], v7 offset:3072
    s_waitcnt lgkmcnt(4)
    v_mfma_f32_32x32x16_bf16 v[12:27], v[124:127], v[76:79], v[12:27]
    s_add_u32 s64, s63, 23
    s_cmp_ge_u32 s64, 28
    s_cselect_b32 s48, 28, 0
    s_sub_u32 s64, s64, s48
    s_lshl_b32 s49, s64, 14
    s_add_u32 s49, s49, s59
    s_add_u32 m0, s61, 10240
    s_add_u32 s3, s49, 0
    buffer_load_dwordx4 v10, s[28:31], s3 offen lds
    s_setprio 1
    v_mfma_f32_32x32x16_bf16 v[44:59], v[128:131], v[76:79], v[44:59]
    s_setprio 0
    s_add_u32 m0, s61, 11264
    s_add_u32 s3, s49, 8192
    buffer_load_dwordx4 v10, s[28:31], s3 offen lds
    v_mfma_f32_32x32x16_bf16 v[28:43], v[124:127], v[80:83], v[28:43]
    s_setprio 1
    v_mfma_f32_32x32x16_bf16 v[60:75], v[128:131], v[80:83], v[60:75]
    s_setprio 0
    s_add_u32 s64, s63, 23
    s_cmp_ge_u32 s64, 28
    s_cselect_b32 s48, 28, 0
    s_sub_u32 s64, s64, s48
    s_lshl_b32 s50, s64, 10
    s_add_u32 s50, s50, s60
    s_add_u32 s3, s50, 0
    buffer_load_dwordx4 v[116:119], v8, s[40:43], s3 offen
    s_add_u32 s3, s50, 114688
    buffer_load_dwordx4 v[120:123], v8, s[40:43], s3 offen
    s_waitcnt vmcnt(14)
    ds_read_b64_tr_b16 v[124:125], v6 offset:4096
    ds_read_b64_tr_b16 v[126:127], v6 offset:5120
    ds_read_b64_tr_b16 v[128:129], v7 offset:4096
    ds_read_b64_tr_b16 v[130:131], v7 offset:5120
    s_waitcnt lgkmcnt(4)
    v_mfma_f32_32x32x16_bf16 v[12:27], v[132:135], v[84:87], v[12:27]
    s_add_u32 s64, s63, 24
    s_cmp_ge_u32 s64, 28
    s_cselect_b32 s48, 28, 0
    s_sub_u32 s64, s64, s48
    s_lshl_b32 s49, s64, 14
    s_add_u32 s49, s49, s59
    s_add_u32 m0, s61, 0
    s_add_u32 s3, s49, 0
    buffer_load_dwordx4 v10, s[28:31], s3 offen lds
    s_setprio 1
    v_mfma_f32_32x32x16_bf16 v[44:59], v[136:139], v[84:87], v[44:59]
    s_setprio 0
    s_add_u32 m0, s61, 1024
    s_add_u32 s3, s49, 8192
    buffer_load_dwordx4 v10, s[28:31], s3 offen lds
    v_mfma_f32_32x32x16_bf16 v[28:43], v[132:135], v[88:91], v[28:43]
    s_setprio 1
    v_mfma_f32_32x32x16_bf16 v[60:75], v[136:139], v[88:91], v[60:75]
    s_setprio 0
    s_add_u32 s64, s63, 24
    s_cmp_ge_u32 s64, 28
    s_cselect_b32 s48, 28, 0
    s_sub_u32 s64, s64, s48
    s_lshl_b32 s50, s64, 10
    s_add_u32 s50, s50, s60
    s_add_u32 s3, s50, 0
    buffer_load_dwordx4 v[76:79], v8, s[40:43], s3 offen
    s_add_u32 s3, s50, 114688
    buffer_load_dwordx4 v[80:83], v8, s[40:43], s3 offen
    s_waitcnt vmcnt(14)
    ds_read_b64_tr_b16 v[132:133], v6 offset:6144
    ds_read_b64_tr_b16 v[134:135], v6 offset:7168
    ds_read_b64_tr_b16 v[136:137], v7 offset:6144
    ds_read_b64_tr_b16 v[138:139], v7 offset:7168
    s_waitcnt lgkmcnt(4)
    v_mfma_f32_32x32x16_bf16 v[12:27], v[124:127], v[92:95], v[12:27]
    s_add_u32 s64, s63, 25
    s_cmp_ge_u32 s64, 28
    s_cselect_b32 s48, 28, 0
    s_sub_u32 s64, s64, s48
    s_lshl_b32 s49, s64, 14
    s_add_u32 s49, s49, s59
    s_add_u32 m0, s61, 2048
    s_add_u32 s3, s49, 0
    buffer_load_dwordx4 v10, s[28:31], s3 offen lds
    s_setprio 1
    v_mfma_f32_32x32x16_bf16 v[44:59], v[128:131], v[92:95], v[44:59]
    s_setprio 0
    s_add_u32 m0, s61, 3072
    s_add_u32 s3, s49, 8192
    buffer_load_dwordx4 v10, s[28:31], s3 offen lds
    v_mfma_f32_32x32x16_bf16 v[28:43], v[124:127], v[96:99], v[28:43]
    s_setprio 1
    v_mfma_f32_32x32x16_bf16 v[60:75], v[128:131], v[96:99], v[60:75]
    s_setprio 0
    s_add_u32 s64, s63, 25
    s_cmp_ge_u32 s64, 28
    s_cselect_b32 s48, 28, 0
    s_sub_u32 s64, s64, s48
    s_lshl_b32 s50, s64, 10
    s_add_u32 s50, s50, s60
    s_add_u32 s3, s50, 0
    buffer_load_dwordx4 v[84:87], v8, s[40:43], s3 offen
    s_add_u32 s3, s50, 114688
    buffer_load_dwordx4 v[88:91], v8, s[40:43], s3 offen
    s_waitcnt vmcnt(14)
    ds_read_b64_tr_b16 v[124:125], v6 offset:8192
    ds_read_b64_tr_b16 v[126:127], v6 offset:9216
    ds_read_b64_tr_b16 v[128:129], v7 offset:8192
    ds_read_b64_tr_b16 v[130:131], v7 offset:9216
    s_waitcnt lgkmcnt(4)
    v_mfma_f32_32x32x16_bf16 v[12:27], v[132:135], v[100:103], v[12:27]
    s_add_u32 s64, s63, 26
    s_cmp_ge_u32 s64, 28
    s_cselect_b32 s48, 28, 0
    s_sub_u32 s64, s64, s48
    s_lshl_b32 s49, s64, 14
    s_add_u32 s49, s49, s59
    s_add_u32 m0, s61, 4096
    s_add_u32 s3, s49, 0
    buffer_load_dwordx4 v10, s[28:31], s3 offen lds
    s_setprio 1
    v_mfma_f32_32x32x16_bf16 v[44:59], v[136:139], v[100:103], v[44:59]
    s_setprio 0
    s_add_u32 m0, s61, 5120
    s_add_u32 s3, s49, 8192
    buffer_load_dwordx4 v10, s[28:31], s3 offen lds
    v_mfma_f32_32x32x16_bf16 v[28:43], v[132:135], v[104:107], v[28:43]
    s_setprio 1
    v_mfma_f32_32x32x16_bf16 v[60:75], v[136:139], v[104:107], v[60:75]
    s_setprio 0
    s_add_u32 s64, s63, 26
    s_cmp_ge_u32 s64, 28
    s_cselect_b32 s48, 28, 0
    s_sub_u32 s64, s64, s48
    s_lshl_b32 s50, s64, 10
    s_add_u32 s50, s50, s60
    s_add_u32 s3, s50, 0
    buffer_load_dwordx4 v[92:95], v8, s[40:43], s3 offen
    s_add_u32 s3, s50, 114688
    buffer_load_dwordx4 v[96:99], v8, s[40:43], s3 offen
    s_waitcnt vmcnt(14)
    ds_read_b64_tr_b16 v[132:133], v6 offset:10240
    ds_read_b64_tr_b16 v[134:135], v6 offset:11264
    ds_read_b64_tr_b16 v[136:137], v7 offset:10240
    ds_read_b64_tr_b16 v[138:139], v7 offset:11264
    s_waitcnt lgkmcnt(4)
    v_mfma_f32_32x32x16_bf16 v[12:27], v[124:127], v[108:111], v[12:27]
    s_add_u32 s64, s63, 27
    s_cmp_ge_u32 s64, 28
    s_cselect_b32 s48, 28, 0
    s_sub_u32 s64, s64, s48
    s_lshl_b32 s49, s64, 14
    s_add_u32 s49, s49, s59
    s_add_u32 m0, s61, 6144
    s_add_u32 s3, s49, 0
    buffer_load_dwordx4 v10, s[28:31], s3 offen lds
    s_setprio 1
    v_mfma_f32_32x32x16_bf16 v[44:59], v[128:131], v[108:111], v[44:59]
    s_setprio 0
    s_add_u32 m0, s61, 7168
    s_add_u32 s3, s49, 8192
    buffer_load_dwordx4 v10, s[28:31], s3 offen lds
    v_mfma_f32_32x32x16_bf16 v[28:43], v[124:127], v[112:115], v[28:43]
    s_setprio 1
    v_mfma_f32_32x32x16_bf16 v[60:75], v[128:131], v[112:115], v[60:75]
    s_setprio 0
    s_add_u32 s64, s63, 27
    s_cmp_ge_u32 s64, 28
    s_cselect_b32 s48, 28, 0
    s_sub_u32 s64, s64, s48
    s_lshl_b32 s50, s64, 10
    s_add_u32 s50, s50, s60
    s_add_u32 s3, s50, 0
    buffer_load_dwordx4 v[100:103], v8, s[40:43], s3 offen
    s_add_u32 s3, s50, 114688
    buffer_load_dwordx4 v[104:107], v8, s[40:43], s3 offen
    s_waitcnt vmcnt(14)
    ds_read_b64_tr_b16 v[124:125], v6 offset:0
    ds_read_b64_tr_b16 v[126:127], v6 offset:1024
    ds_read_b64_tr_b16 v[128:129], v7 offset:0
    ds_read_b64_tr_b16 v[130:131], v7 offset:1024
    s_waitcnt lgkmcnt(4)
    v_mfma_f32_32x32x16_bf16 v[12:27], v[132:135], v[116:119], v[12:27]
    s_setprio 1
    v_mfma_f32_32x32x16_bf16 v[44:59], v[136:139], v[116:119], v[44:59]
    s_setprio 0
    v_mfma_f32_32x32x16_bf16 v[28:43], v[132:135], v[120:123], v[28:43]
    s_setprio 1
    v_mfma_f32_32x32x16_bf16 v[60:75], v[136:139], v[120:123], v[60:75]
    s_setprio 0
    s_waitcnt vmcnt(10)
    ds_read_b64_tr_b16 v[132:133], v6 offset:2048
    ds_read_b64_tr_b16 v[134:135], v6 offset:3072
    ds_read_b64_tr_b16 v[136:137], v7 offset:2048
    ds_read_b64_tr_b16 v[138:139], v7 offset:3072
    s_waitcnt lgkmcnt(4)
    v_mfma_f32_32x32x16_bf16 v[12:27], v[124:127], v[76:79], v[12:27]
    s_setprio 1
    v_mfma_f32_32x32x16_bf16 v[44:59], v[128:131], v[76:79], v[44:59]
    s_setprio 0
    v_mfma_f32_32x32x16_bf16 v[28:43], v[124:127], v[80:83], v[28:43]
    s_setprio 1
    v_mfma_f32_32x32x16_bf16 v[60:75], v[128:131], v[80:83], v[60:75]
    s_setprio 0
    s_waitcnt vmcnt(6)
    ds_read_b64_tr_b16 v[124:125], v6 offset:4096
    ds_read_b64_tr_b16 v[126:127], v6 offset:5120
    ds_read_b64_tr_b16 v[128:129], v7 offset:4096
    ds_read_b64_tr_b16 v[130:131], v7 offset:5120
    s_waitcnt lgkmcnt(4)
    v_mfma_f32_32x32x16_bf16 v[12:27], v[132:135], v[84:87], v[12:27]
    s_setprio 1
    v_mfma_f32_32x32x16_bf16 v[44:59], v[136:139], v[84:87], v[44:59]
    s_setprio 0
    v_mfma_f32_32x32x16_bf16 v[28:43], v[132:135], v[88:91], v[28:43]
    s_setprio 1
    v_mfma_f32_32x32x16_bf16 v[60:75], v[136:139], v[88:91], v[60:75]
    s_setprio 0
    s_waitcnt vmcnt(2)
    ds_read_b64_tr_b16 v[132:133], v6 offset:6144
    ds_read_b64_tr_b16 v[134:135], v6 offset:7168
    ds_read_b64_tr_b16 v[136:137], v7 offset:6144
    ds_read_b64_tr_b16 v[138:139], v7 offset:7168
    s_waitcnt lgkmcnt(4)
    v_mfma_f32_32x32x16_bf16 v[12:27], v[124:127], v[92:95], v[12:27]
    s_setprio 1
    v_mfma_f32_32x32x16_bf16 v[44:59], v[128:131], v[92:95], v[44:59]
    s_setprio 0
    v_mfma_f32_32x32x16_bf16 v[28:43], v[124:127], v[96:99], v[28:43]
    s_setprio 1
    v_mfma_f32_32x32x16_bf16 v[60:75], v[128:131], v[96:99], v[60:75]
    s_setprio 0
    s_waitcnt vmcnt(0)
    s_waitcnt lgkmcnt(0)
    v_mfma_f32_32x32x16_bf16 v[12:27], v[132:135], v[100:103], v[12:27]
    s_setprio 1
    v_mfma_f32_32x32x16_bf16 v[44:59], v[136:139], v[100:103], v[44:59]
    s_setprio 0
    v_mfma_f32_32x32x16_bf16 v[28:43], v[132:135], v[104:107], v[28:43]
    s_setprio 1
    v_mfma_f32_32x32x16_bf16 v[60:75], v[136:139], v[104:107], v[60:75]
    s_setprio 0
    s_add_u32 m0, s62, 0
    s_add_u32 s3, s57, 0
    buffer_load_dwordx4 v10, s[16:19], s3 offen lds
    s_add_u32 m0, s62, 1024
    s_add_u32 s3, s57, 8192
    buffer_load_dwordx4 v10, s[16:19], s3 offen lds
    s_add_u32 m0, s62, 2048
    s_add_u32 s3, s57, 16384
    buffer_load_dwordx4 v10, s[16:19], s3 offen lds
    s_add_u32 m0, s62, 3072
    s_add_u32 s3, s57, 24576
    buffer_load_dwordx4 v10, s[16:19], s3 offen lds
    s_add_u32 m0, s62, 4096
    s_add_u32 s3, s57, 32768
    buffer_load_dwordx4 v10, s[16:19], s3 offen lds
    s_add_u32 m0, s62, 5120
    s_add_u32 s3, s57, 40960
    buffer_load_dwordx4 v10, s[16:19], s3 offen lds
    s_add_u32 m0, s62, 6144
    s_add_u32 s3, s57, 49152
    buffer_load_dwordx4 v10, s[16:19], s3 offen lds
    s_add_u32 m0, s62, 7168
    s_add_u32 s3, s57, 57344
    buffer_load_dwordx4 v10, s[16:19], s3 offen lds
    s_add_u32 m0, s62, 8192
    s_add_u32 s3, s57, 65536
    buffer_load_dwordx4 v10, s[16:19], s3 offen lds
    s_add_u32 m0, s62, 9216
    s_add_u32 s3, s57, 73728
    buffer_load_dwordx4 v10, s[16:19], s3 offen lds
    s_add_u32 m0, s62, 10240
    s_add_u32 s3, s57, 81920
    buffer_load_dwordx4 v10, s[16:19], s3 offen lds
    s_add_u32 m0, s62, 11264
    s_add_u32 s3, s57, 90112
    buffer_load_dwordx4 v10, s[16:19], s3 offen lds
    s_add_u32 m0, s62, 12288
    s_add_u32 s3, s57, 98304
    buffer_load_dwordx4 v10, s[16:19], s3 offen lds
    s_add_u32 m0, s62, 13312
    s_add_u32 s3, s57, 106496
    buffer_load_dwordx4 v10, s[16:19], s3 offen lds
    s_add_u32 m0, s62, 14336
    s_add_u32 s3, s57, 114688
    buffer_load_dwordx4 v10, s[16:19], s3 offen lds
    s_add_u32 m0, s62, 15360
    s_add_u32 s3, s57, 122880
    buffer_load_dwordx4 v10, s[16:19], s3 offen lds
    s_setprio 1
    s_nop 7
    v_add_u32 v6, s61, v8
    s_nop 3
    s_cmp_eq_u32 s54, 0
    s_cbranch_scc1 gated_mix__mha_block__glu_gated_reglu__prompt_kernel_d_w0
    s_sub_u32 s48, 3, s54
    s_and_b32 s48, s48, 3
    s_lshl_b32 s48, s48, 12
    v_add_u32 v7, s48, v6
    ds_write_b128 v7, v[12:15] offset:0
    ds_write_b128 v7, v[16:19] offset:1024
    ds_write_b128 v7, v[20:23] offset:2048
    ds_write_b128 v7, v[24:27] offset:3072
gated_mix__mha_block__glu_gated_reglu__prompt_kernel_d_w0:
    s_cmp_eq_u32 s54, 1
    s_cbranch_scc1 gated_mix__mha_block__glu_gated_reglu__prompt_kernel_d_w1
    s_sub_u32 s48, 4, s54
    s_and_b32 s48, s48, 3
    s_lshl_b32 s48, s48, 12
    v_add_u32 v7, s48, v6
    ds_write_b128 v7, v[28:31] offset:0
    ds_write_b128 v7, v[32:35] offset:1024
    ds_write_b128 v7, v[36:39] offset:2048
    ds_write_b128 v7, v[40:43] offset:3072
gated_mix__mha_block__glu_gated_reglu__prompt_kernel_d_w1:
    s_cmp_eq_u32 s54, 2
    s_cbranch_scc1 gated_mix__mha_block__glu_gated_reglu__prompt_kernel_d_w2
    s_sub_u32 s48, 5, s54
    s_and_b32 s48, s48, 3
    s_lshl_b32 s48, s48, 12
    v_add_u32 v7, s48, v6
    ds_write_b128 v7, v[44:47] offset:0
    ds_write_b128 v7, v[48:51] offset:1024
    ds_write_b128 v7, v[52:55] offset:2048
    ds_write_b128 v7, v[56:59] offset:3072
gated_mix__mha_block__glu_gated_reglu__prompt_kernel_d_w2:
    s_cmp_eq_u32 s54, 3
    s_cbranch_scc1 gated_mix__mha_block__glu_gated_reglu__prompt_kernel_d_w3
    s_sub_u32 s48, 6, s54
    s_and_b32 s48, s48, 3
    s_lshl_b32 s48, s48, 12
    v_add_u32 v7, s48, v6
    ds_write_b128 v7, v[60:63] offset:0
    ds_write_b128 v7, v[64:67] offset:1024
    ds_write_b128 v7, v[68:71] offset:2048
    ds_write_b128 v7, v[72:75] offset:3072
gated_mix__mha_block__glu_gated_reglu__prompt_kernel_d_w3:
    s_cmp_lg_u32 s54, 0
    s_cbranch_scc1 gated_mix__mha_block__glu_gated_reglu__prompt_kernel_d_m0
    v_mov_b32 v76, v12
    v_mov_b32 v77, v13
    v_mov_b32 v78, v14
    v_mov_b32 v79, v15
    v_mov_b32 v80, v16
    v_mov_b32 v81, v17
    v_mov_b32 v82, v18
    v_mov_b32 v83, v19
    v_mov_b32 v84, v20
    v_mov_b32 v85, v21
    v_mov_b32 v86, v22
    v_mov_b32 v87, v23
    v_mov_b32 v88, v24
    v_mov_b32 v89, v25
    v_mov_b32 v90, v26
    v_mov_b32 v91, v27
gated_mix__mha_block__glu_gated_reglu__prompt_kernel_d_m0:
    s_cmp_lg_u32 s54, 1
    s_cbranch_scc1 gated_mix__mha_block__glu_gated_reglu__prompt_kernel_d_m1
    v_mov_b32 v76, v28
    v_mov_b32 v77, v29
    v_mov_b32 v78, v30
    v_mov_b32 v79, v31
    v_mov_b32 v80, v32
    v_mov_b32 v81, v33
    v_mov_b32 v82, v34
    v_mov_b32 v83, v35
    v_mov_b32 v84, v36
    v_mov_b32 v85, v37
    v_mov_b32 v86, v38
    v_mov_b32 v87, v39
    v_mov_b32 v88, v40
    v_mov_b32 v89, v41
    v_mov_b32 v90, v42
    v_mov_b32 v91, v43
gated_mix__mha_block__glu_gated_reglu__prompt_kernel_d_m1:
    s_cmp_lg_u32 s54, 2
    s_cbranch_scc1 gated_mix__mha_block__glu_gated_reglu__prompt_kernel_d_m2
    v_mov_b32 v76, v44
    v_mov_b32 v77, v45
    v_mov_b32 v78, v46
    v_mov_b32 v79, v47
    v_mov_b32 v80, v48
    v_mov_b32 v81, v49
    v_mov_b32 v82, v50
    v_mov_b32 v83, v51
    v_mov_b32 v84, v52
    v_mov_b32 v85, v53
    v_mov_b32 v86, v54
    v_mov_b32 v87, v55
    v_mov_b32 v88, v56
    v_mov_b32 v89, v57
    v_mov_b32 v90, v58
    v_mov_b32 v91, v59
gated_mix__mha_block__glu_gated_reglu__prompt_kernel_d_m2:
    s_cmp_lg_u32 s54, 3
    s_cbranch_scc1 gated_mix__mha_block__glu_gated_reglu__prompt_kernel_d_m3
    v_mov_b32 v76, v60
    v_mov_b32 v77, v61
    v_mov_b32 v78, v62
    v_mov_b32 v79, v63
    v_mov_b32 v80, v64
    v_mov_b32 v81, v65
    v_mov_b32 v82, v66
    v_mov_b32 v83, v67
    v_mov_b32 v84, v68
    v_mov_b32 v85, v69
    v_mov_b32 v86, v70
    v_mov_b32 v87, v71
    v_mov_b32 v88, v72
    v_mov_b32 v89, v73
    v_mov_b32 v90, v74
    v_mov_b32 v91, v75
gated_mix__mha_block__glu_gated_reglu__prompt_kernel_d_m3:
    v_mov_b32 v2, 155712
    v_mov_b32 v3, 1
    s_waitcnt lgkmcnt(0)
    s_mov_b64 exec, 1
    ds_add_u32 v2, v3 offset:12
    s_mov_b64 exec, -1
    s_mov_b32 s58, 1600000
gated_mix__mha_block__glu_gated_reglu__prompt_kernel_d_spinr:
    ds_read_b32 v4, v2 offset:12
    s_waitcnt lgkmcnt(0)
    v_readfirstlane_b32 s62, v4
    s_cmp_ge_u32 s62, 4
    s_cbranch_scc1 gated_mix__mha_block__glu_gated_reglu__prompt_kernel_d_spinr_ok
    s_sub_u32 s58, s58, 1
    s_cmp_eq_u32 s58, 0
    s_cbranch_scc1 gated_mix__mha_block__glu_gated_reglu__prompt_kernel_d_spinr_ok
    s_sleep 1
    s_branch gated_mix__mha_block__glu_gated_reglu__prompt_kernel_d_spinr
gated_mix__mha_block__glu_gated_reglu__prompt_kernel_d_spinr_ok:
    s_add_u32 s48, s54, 1
    s_and_b32 s48, s48, 3
    s_mul_i32 s48, s48, 12288
    s_add_u32 s48, s48, 73728
    v_add_u32 v7, s48, v8
    ds_read_b128 v[12:15], v7 offset:0
    ds_read_b128 v[16:19], v7 offset:1024
    ds_read_b128 v[20:23], v7 offset:2048
    ds_read_b128 v[24:27], v7 offset:3072
    s_add_u32 s48, s54, 2
    s_and_b32 s48, s48, 3
    s_mul_i32 s48, s48, 12288
    s_add_u32 s48, s48, 69632
    v_add_u32 v7, s48, v8
    ds_read_b128 v[28:31], v7 offset:0
    ds_read_b128 v[32:35], v7 offset:1024
    ds_read_b128 v[36:39], v7 offset:2048
    ds_read_b128 v[40:43], v7 offset:3072
    s_add_u32 s48, s54, 3
    s_and_b32 s48, s48, 3
    s_mul_i32 s48, s48, 12288
    s_add_u32 s48, s48, 65536
    v_add_u32 v7, s48, v8
    ds_read_b128 v[44:47], v7 offset:0
    ds_read_b128 v[48:51], v7 offset:1024
    ds_read_b128 v[52:55], v7 offset:2048
    ds_read_b128 v[56:59], v7 offset:3072
    s_waitcnt lgkmcnt(0)
    v_add_f32 v76, v76, v12
    v_add_f32 v77, v77, v13
    v_add_f32 v78, v78, v14
    v_add_f32 v79, v79, v15
    v_add_f32 v80, v80, v16
    v_add_f32 v81, v81, v17
    v_add_f32 v82, v82, v18
    v_add_f32 v83, v83, v19
    v_add_f32 v84, v84, v20
    v_add_f32 v85, v85, v21
    v_add_f32 v86, v86, v22
    v_add_f32 v87, v87, v23
    v_add_f32 v88, v88, v24
    v_add_f32 v89, v89, v25
    v_add_f32 v90, v90, v26
    v_add_f32 v91, v91, v27
    v_add_f32 v76, v76, v28
    v_add_f32 v77, v77, v29
    v_add_f32 v78, v78, v30
    v_add_f32 v79, v79, v31
    v_add_f32 v80, v80, v32
    v_add_f32 v81, v81, v33
    v_add_f32 v82, v82, v34
    v_add_f32 v83, v83, v35
    v_add_f32 v84, v84, v36
    v_add_f32 v85, v85, v37
    v_add_f32 v86, v86, v38
    v_add_f32 v87, v87, v39
    v_add_f32 v88, v88, v40
    v_add_f32 v89, v89, v41
    v_add_f32 v90, v90, v42
    v_add_f32 v91, v91, v43
    v_add_f32 v76, v76, v44
    v_add_f32 v77, v77, v45
    v_add_f32 v78, v78, v46
    v_add_f32 v79, v79, v47
    v_add_f32 v80, v80, v48
    v_add_f32 v81, v81, v49
    v_add_f32 v82, v82, v50
    v_add_f32 v83, v83, v51
    v_add_f32 v84, v84, v52
    v_add_f32 v85, v85, v53
    v_add_f32 v86, v86, v54
    v_add_f32 v87, v87, v55
    v_add_f32 v88, v88, v56
    v_add_f32 v89, v89, v57
    v_add_f32 v90, v90, v58
    v_add_f32 v91, v91, v59
    v_and_b32 v2, 15, v1
    v_lshrrev_b32 v2, 2, v2
    v_lshlrev_b32 v6, 7, v2
    v_lshrrev_b32 v2, 1, v2
    v_xor_b32 v2, s56, v2
    v_lshlrev_b32 v2, 6, v2
    v_add_u32 v6, v6, v2
    v_lshlrev_b32 v2, 1, v1
    v_and_b32 v2, 32, v2
    v_add_u32 v6, v6, v2
    v_and_b32 v2, 3, v1
    v_lshlrev_b32 v2, 3, v2
    v_add_u32 v6, v6, v2
    v_lshrrev_b32 v2, 5, v1
    v_mul_u32_u24 v2, 512, v2
    v_add_u32 v6, v6, v2
    s_lshl_b32 s48, s55, 15
    s_add_u32 s48, s48, 65536
    v_add_u32 v11, s48, v8
    s_waitcnt vmcnt(0)
    s_barrier
    s_barrier
    ds_read_b128 v[28:31], v11 offset:0
    ds_read_b64_tr_b16 v[52:53], v6 offset:0
    ds_read_b64_tr_b16 v[54:55], v6 offset:1024
    ds_read_b128 v[32:35], v11 offset:1024
    ds_read_b64_tr_b16 v[56:57], v6 offset:2048
    ds_read_b64_tr_b16 v[58:59], v6 offset:3072
    ds_read_b128 v[36:39], v11 offset:2048
    ds_read_b64_tr_b16 v[92:93], v6 offset:4096
    ds_read_b64_tr_b16 v[94:95], v6 offset:5120
    ds_read_b128 v[40:43], v11 offset:3072
    ds_read_b64_tr_b16 v[96:97], v6 offset:6144
    ds_read_b64_tr_b16 v[98:99], v6 offset:7168
    ds_read_b128 v[44:47], v11 offset:4096
    ds_read_b64_tr_b16 v[100:101], v6 offset:8192
    ds_read_b64_tr_b16 v[102:103], v6 offset:9216
    s_waitcnt lgkmcnt(12)
    v_mfma_f32_32x32x16_bf16 v[12:27], v[52:55], v[28:31], 0
    ds_read_b128 v[48:51], v11 offset:5120
    ds_read_b64_tr_b16 v[104:105], v6 offset:10240
    ds_read_b64_tr_b16 v[106:107], v6 offset:11264
    s_waitcnt lgkmcnt(12)
    v_mfma_f32_32x32x16_bf16 v[12:27], v[56:59], v[32:35], v[12:27]
    ds_read_b128 v[28:31], v11 offset:6144
    ds_read_b64_tr_b16 v[52:53], v6 offset:12288
    ds_read_b64_tr_b16 v[54:55], v6 offset:13312
    s_waitcnt lgkmcnt(12)
    v_mfma_f32_32x32x16_bf16 v[12:27], v[92:95], v[36:39], v[12:27]
    ds_read_b128 v[32:35], v11 offset:7168
    ds_read_b64_tr_b16 v[56:57], v6 offset:14336
    ds_read_b64_tr_b16 v[58:59], v6 offset:15360
    s_waitcnt lgkmcnt(12)
    v_mfma_f32_32x32x16_bf16 v[12:27], v[96:99], v[40:43], v[12:27]
    ds_read_b128 v[36:39], v11 offset:8192
    ds_read_b64_tr_b16 v[92:93], v6 offset:16384
    ds_read_b64_tr_b16 v[94:95], v6 offset:17408
    s_waitcnt lgkmcnt(12)
    v_mfma_f32_32x32x16_bf16 v[12:27], v[100:103], v[44:47], v[12:27]
    ds_read_b128 v[40:43], v11 offset:9216
    ds_read_b64_tr_b16 v[96:97], v6 offset:18432
    ds_read_b64_tr_b16 v[98:99], v6 offset:19456
    s_waitcnt lgkmcnt(12)
    v_mfma_f32_32x32x16_bf16 v[12:27], v[104:107], v[48:51], v[12:27]
    ds_read_b128 v[44:47], v11 offset:10240
    ds_read_b64_tr_b16 v[100:101], v6 offset:20480
    ds_read_b64_tr_b16 v[102:103], v6 offset:21504
    s_waitcnt lgkmcnt(12)
    v_mfma_f32_32x32x16_bf16 v[12:27], v[52:55], v[28:31], v[12:27]
    ds_read_b128 v[48:51], v11 offset:11264
    ds_read_b64_tr_b16 v[104:105], v6 offset:22528
    ds_read_b64_tr_b16 v[106:107], v6 offset:23552
    s_waitcnt lgkmcnt(12)
    v_mfma_f32_32x32x16_bf16 v[12:27], v[56:59], v[32:35], v[12:27]
    ds_read_b128 v[28:31], v11 offset:12288
    ds_read_b64_tr_b16 v[52:53], v6 offset:24576
    ds_read_b64_tr_b16 v[54:55], v6 offset:25600
    s_waitcnt lgkmcnt(12)
    v_mfma_f32_32x32x16_bf16 v[12:27], v[92:95], v[36:39], v[12:27]
    ds_read_b128 v[32:35], v11 offset:13312
    ds_read_b64_tr_b16 v[56:57], v6 offset:26624
    ds_read_b64_tr_b16 v[58:59], v6 offset:27648
    s_waitcnt lgkmcnt(12)
    v_mfma_f32_32x32x16_bf16 v[12:27], v[96:99], v[40:43], v[12:27]
    ds_read_b128 v[36:39], v11 offset:14336
    ds_read_b64_tr_b16 v[92:93], v6 offset:28672
    ds_read_b64_tr_b16 v[94:95], v6 offset:29696
    s_waitcnt lgkmcnt(12)
    v_mfma_f32_32x32x16_bf16 v[12:27], v[100:103], v[44:47], v[12:27]
    ds_read_b128 v[40:43], v11 offset:15360
    ds_read_b64_tr_b16 v[96:97], v6 offset:30720
    ds_read_b64_tr_b16 v[98:99], v6 offset:31744
    s_waitcnt lgkmcnt(12)
    v_mfma_f32_32x32x16_bf16 v[12:27], v[104:107], v[48:51], v[12:27]
    ds_read_b128 v[44:47], v11 offset:16384
    ds_read_b64_tr_b16 v[100:101], v6 offset:32768
    ds_read_b64_tr_b16 v[102:103], v6 offset:33792
    s_waitcnt lgkmcnt(12)
    v_mfma_f32_32x32x16_bf16 v[12:27], v[52:55], v[28:31], v[12:27]
    ds_read_b128 v[48:51], v11 offset:17408
    ds_read_b64_tr_b16 v[104:105], v6 offset:34816
    ds_read_b64_tr_b16 v[106:107], v6 offset:35840
    s_waitcnt lgkmcnt(12)
    v_mfma_f32_32x32x16_bf16 v[12:27], v[56:59], v[32:35], v[12:27]
    ds_read_b128 v[28:31], v11 offset:18432
    ds_read_b64_tr_b16 v[52:53], v6 offset:36864
    ds_read_b64_tr_b16 v[54:55], v6 offset:37888
    s_waitcnt lgkmcnt(12)
    v_mfma_f32_32x32x16_bf16 v[12:27], v[92:95], v[36:39], v[12:27]
    ds_read_b128 v[32:35], v11 offset:19456
    ds_read_b64_tr_b16 v[56:57], v6 offset:38912
    ds_read_b64_tr_b16 v[58:59], v6 offset:39936
    s_waitcnt lgkmcnt(12)
    v_mfma_f32_32x32x16_bf16 v[12:27], v[96:99], v[40:43], v[12:27]
    ds_read_b128 v[36:39], v11 offset:20480
    ds_read_b64_tr_b16 v[92:93], v6 offset:40960
    ds_read_b64_tr_b16 v[94:95], v6 offset:41984
    s_waitcnt lgkmcnt(12)
    v_mfma_f32_32x32x16_bf16 v[12:27], v[100:103], v[44:47], v[12:27]
    ds_read_b128 v[40:43], v11 offset:21504
    ds_read_b64_tr_b16 v[96:97], v6 offset:43008
    ds_read_b64_tr_b16 v[98:99], v6 offset:44032
    s_waitcnt lgkmcnt(12)
    v_mfma_f32_32x32x16_bf16 v[12:27], v[104:107], v[48:51], v[12:27]
    ds_read_b128 v[44:47], v11 offset:22528
    ds_read_b64_tr_b16 v[100:101], v6 offset:45056
    ds_read_b64_tr_b16 v[102:103], v6 offset:46080
    s_waitcnt lgkmcnt(12)
    v_mfma_f32_32x32x16_bf16 v[12:27], v[52:55], v[28:31], v[12:27]
    ds_read_b128 v[48:51], v11 offset:23552
    ds_read_b64_tr_b16 v[104:105], v6 offset:47104
    ds_read_b64_tr_b16 v[106:107], v6 offset:48128
    s_waitcnt lgkmcnt(12)
    v_mfma_f32_32x32x16_bf16 v[12:27], v[56:59], v[32:35], v[12:27]
    ds_read_b128 v[28:31], v11 offset:24576
    ds_read_b64_tr_b16 v[52:53], v6 offset:49152
    ds_read_b64_tr_b16 v[54:55], v6 offset:50176
    s_waitcnt lgkmcnt(12)
    v_mfma_f32_32x32x16_bf16 v[12:27], v[92:95], v[36:39], v[12:27]
    ds_read_b128 v[32:35], v11 offset:25600
    ds_read_b64_tr_b16 v[56:57], v6 offset:51200
    ds_read_b64_tr_b16 v[58:59], v6 offset:52224
    s_waitcnt lgkmcnt(12)
    v_mfma_f32_32x32x16_bf16 v[12:27], v[96:99], v[40:43], v[12:27]
    ds_read_b128 v[36:39], v11 offset:26624
    ds_read_b64_tr_b16 v[92:93], v6 offset:53248
    ds_read_b64_tr_b16 v[94:95], v6 offset:54272
    s_waitcnt lgkmcnt(12)
    v_mfma_f32_32x32x16_bf16 v[12:27], v[100:103], v[44:47], v[12:27]
    ds_read_b128 v[40:43], v11 offset:27648
    ds_read_b64_tr_b16 v[96:97], v6 offset:55296
    ds_read_b64_tr_b16 v[98:99], v6 offset:56320
    s_waitcnt lgkmcnt(12)
    v_mfma_f32_32x32x16_bf16 v[12:27], v[104:107], v[48:51], v[12:27]
    ds_read_b128 v[44:47], v11 offset:28672
    ds_read_b64_tr_b16 v[100:101], v6 offset:57344
    ds_read_b64_tr_b16 v[102:103], v6 offset:58368
    s_waitcnt lgkmcnt(12)
    v_mfma_f32_32x32x16_bf16 v[12:27], v[52:55], v[28:31], v[12:27]
    ds_read_b128 v[48:51], v11 offset:29696
    ds_read_b64_tr_b16 v[104:105], v6 offset:59392
    ds_read_b64_tr_b16 v[106:107], v6 offset:60416
    s_waitcnt lgkmcnt(12)
    v_mfma_f32_32x32x16_bf16 v[12:27], v[56:59], v[32:35], v[12:27]
    ds_read_b128 v[28:31], v11 offset:30720
    ds_read_b64_tr_b16 v[52:53], v6 offset:61440
    ds_read_b64_tr_b16 v[54:55], v6 offset:62464
    s_waitcnt lgkmcnt(12)
    v_mfma_f32_32x32x16_bf16 v[12:27], v[92:95], v[36:39], v[12:27]
    ds_read_b128 v[32:35], v11 offset:31744
    ds_read_b64_tr_b16 v[56:57], v6 offset:63488
    ds_read_b64_tr_b16 v[58:59], v6 offset:64512
    s_waitcnt lgkmcnt(12)
    v_mfma_f32_32x32x16_bf16 v[12:27], v[96:99], v[40:43], v[12:27]
    s_waitcnt lgkmcnt(9)
    v_mfma_f32_32x32x16_bf16 v[12:27], v[100:103], v[44:47], v[12:27]
    s_waitcnt lgkmcnt(6)
    v_mfma_f32_32x32x16_bf16 v[12:27], v[104:107], v[48:51], v[12:27]
    s_waitcnt lgkmcnt(3)
    v_mfma_f32_32x32x16_bf16 v[12:27], v[52:55], v[28:31], v[12:27]
    s_waitcnt lgkmcnt(0)
    v_mfma_f32_32x32x16_bf16 v[12:27], v[56:59], v[32:35], v[12:27]
    s_lshl_b32 s48, s52, 16
    s_lshl_b32 s49, s55, 15
    s_add_u32 s48, s48, s49
    s_lshl_b32 s49, s53, 7
    s_add_u32 s48, s48, s49
    s_lshl_b32 s49, s56, 6
    s_add_u32 s48, s48, s49
    v_and_b32 v2, 31, v1
    v_lshlrev_b32 v2, 10, v2
    v_lshrrev_b32 v3, 5, v1
    v_lshlrev_b32 v3, 4, v3
    v_add_u32 v2, v2, v3
    s_nop 0
    v_sub_f32 v12, v12, v76
    v_sub_f32 v13, v13, v77
    v_sub_f32 v14, v14, v78
    v_sub_f32 v15, v15, v79
    v_sub_f32 v16, v16, v80
    v_sub_f32 v17, v17, v81
    v_sub_f32 v18, v18, v82
    v_sub_f32 v19, v19, v83
    v_sub_f32 v20, v20, v84
    v_sub_f32 v21, v21, v85
    v_sub_f32 v22, v22, v86
    v_sub_f32 v23, v23, v87
    v_sub_f32 v24, v24, v88
    v_sub_f32 v25, v25, v89
    v_sub_f32 v26, v26, v90
    v_sub_f32 v27, v27, v91
    v_fma_f32 v12, v9, v12, v76
    v_fma_f32 v13, v9, v13, v77
    v_fma_f32 v14, v9, v14, v78
    v_fma_f32 v15, v9, v15, v79
    v_fma_f32 v16, v9, v16, v80
    v_fma_f32 v17, v9, v17, v81
    v_fma_f32 v18, v9, v18, v82
    v_fma_f32 v19, v9, v19, v83
    v_fma_f32 v20, v9, v20, v84
    v_fma_f32 v21, v9, v21, v85
    v_fma_f32 v22, v9, v22, v86
    v_fma_f32 v23, v9, v23, v87
    v_fma_f32 v24, v9, v24, v88
    v_fma_f32 v25, v9, v25, v89
    v_fma_f32 v26, v9, v26, v90
    v_fma_f32 v27, v9, v27, v91
    v_cvt_pk_bf16_f32 v60, v12, v13
    v_cvt_pk_bf16_f32 v61, v14, v15
    v_cvt_pk_bf16_f32 v62, v16, v17
    v_cvt_pk_bf16_f32 v63, v18, v19
    v_cvt_pk_bf16_f32 v64, v20, v21
    v_cvt_pk_bf16_f32 v65, v22, v23
    v_cvt_pk_bf16_f32 v66, v24, v25
    v_cvt_pk_bf16_f32 v67, v26, v27
    s_nop 1
    v_permlane32_swap_b32 v60, v62
    v_permlane32_swap_b32 v61, v63
    v_permlane32_swap_b32 v64, v66
    v_permlane32_swap_b32 v65, v67
    buffer_store_dwordx4 v[60:63], v2, s[36:39], s48 offen
    buffer_store_dwordx4 v[64:67], v2, s[36:39], s48 offen offset:32
gated_mix__mha_block__glu_gated_reglu__prompt_kernel_fin:
    s_waitcnt vmcnt(0)
    s_nop 0
gated_mix__mha_block__glu_gated_reglu__prompt_kernel_end:
    s_endpgm
.section .rodata,"a"
.p2align 6
.amdhsa_kernel gated_mix__mha_block__glu_gated_reglu__prompt_kernel
  .amdhsa_next_free_vgpr 168
  .amdhsa_next_free_sgpr 102
  .amdhsa_accum_offset 168
  .amdhsa_group_segment_fixed_size 0
  .amdhsa_kernarg_size 88
  .amdhsa_user_sgpr_count 2
  .amdhsa_user_sgpr_kernarg_segment_ptr 1
  .amdhsa_system_sgpr_workgroup_id_x 1
  .amdhsa_float_denorm_mode_32 3
.end_amdhsa_kernel
```
